```python
import torch

def _softmax(x, axis=-1):
    return torch.softmax(x, dim=axis)

def _gelu(x):
    return torch.nn.functional.gelu(x, approximate='tanh')

def _silu(x):
    return torch.nn.functional.silu(x)

def _sigmoid(x):
    return torch.sigmoid(x)

def _layernorm(x, axis=-1, eps=1e-05):
    m = x.mean(dim=axis, keepdim=True)
    v = x.var(dim=axis, keepdim=True, unbiased=False)
    return (x - m) / torch.sqrt(v + eps)

def _scatter_add(tgt, idx, src, axis=0):
    return tgt.clone().index_add_(axis, idx, src)

def _segment_sum(src, seg, n):
    out = torch.zeros((n,) + src.shape[1:], dtype=src.dtype)
    return out.index_add_(0, seg, src)

def _pad(x, pw):
    flat = tuple((v for pair in reversed(pw) for v in pair))
    return torch.nn.functional.pad(x, flat)
kernel_name = 'adaLN_cond__spectral_fnet__geglu_ffn__prompt'

def setup_inputs():

    _w = lambda a: (lambda t: t.to(torch.bfloat16) if t.is_floating_point() else t)(torch.as_tensor(a))

    def _A_setup():
        B, S, D = (1, 2048, 1024)
        ns = torch.arange(S)[:, None] * torch.arange(S)[None, :]
        nd = torch.arange(D)[:, None] * torch.arange(D)[None, :]
        Ws_re = torch.cos(-2.0 * torch.pi * ns / S).to(float)
        Ws_im = torch.sin(-2.0 * torch.pi * ns / S).to(float)
        Wd_re = torch.cos(-2.0 * torch.pi * nd / D).to(float)
        Wd_im = torch.sin(-2.0 * torch.pi * nd / D).to(float)
        return {'x': _w((lambda *s: torch.randn(*s, dtype=torch.bfloat16) * 0.05)(B, S, D)), 'dft_seq_re': _w(Ws_re), 'dft_seq_im': _w(Ws_im), 'dft_hid_re': _w(Wd_re), 'dft_hid_im': _w(Wd_im)}
    _A_in = _A_setup()

    def _B_setup():
        B, S, D, F = (1, 2048, 1024, 3584)
        return {'x': _w((lambda *s: torch.randn(*s, dtype=torch.bfloat16) * 0.05)(B, S, D)), 'w_gate': _w((lambda *s: torch.randn(*s, dtype=torch.bfloat16) * 0.4)(D, F)), 'w_up': _w((lambda *s: torch.randn(*s, dtype=torch.bfloat16) * 0.4)(D, F)), 'w_down': _w((lambda *s: torch.randn(*s, dtype=torch.bfloat16) * 0.4)(F, D))}
    _B_in = _B_setup()
    return {'A_x': _A_in['x'], 'A_dft_seq_re': _A_in['dft_seq_re'], 'A_dft_seq_im': _A_in['dft_seq_im'], 'A_dft_hid_re': _A_in['dft_hid_re'], 'A_dft_hid_im': _A_in['dft_hid_im'], 'B_x': _B_in['x'], 'B_w_gate': _B_in['w_gate'], 'B_w_up': _B_in['w_up'], 'B_w_down': _B_in['w_down'], 'c': _w((lambda *s: torch.randn(*s, dtype=torch.bfloat16) * 0.1)(1, 1024) * 8.0), 'w_mod': _w((lambda *s: torch.randn(*s, dtype=torch.bfloat16) * 0.1)(1024, 6 * 1024) * 1024 ** (-0.5) * 8.0)}

def reference(A_x, A_dft_seq_re, A_dft_seq_im, A_dft_hid_re, A_dft_hid_im, B_x, B_w_gate, B_w_up, B_w_down, c, w_mod):

    def _A_ref(x, dft_seq_re, dft_seq_im, dft_hid_re, dft_hid_im):
        a = torch.einsum('bsd,ed->bse', x, dft_hid_re)
        b = torch.einsum('bsd,ed->bse', x, dft_hid_im)
        y = torch.einsum('ts,bse->bte', dft_seq_re, a) - torch.einsum('ts,bse->bte', dft_seq_im, b)
        return y

    def _B_ref(x, w_gate, w_up, w_down):
        return _gelu(x @ w_gate) * (x @ w_up) @ w_down
    x = A_x
    mod = (_silu(c) @ w_mod).reshape(c.shape[0], 6, 1, -1)
    sa, ca, ga, sb, cb, gb = (mod[:, 0].clone(), mod[:, 1].clone(), mod[:, 2].clone(), mod[:, 3].clone(), mod[:, 4].clone(), mod[:, 5].clone())
    h = _layernorm(x, axis=-1) * (1 + ca) + sa
    x = x + ga * _A_ref(h, A_dft_seq_re, A_dft_seq_im, A_dft_hid_re, A_dft_hid_im)
    h = _layernorm(x, axis=-1) * (1 + cb) + sb
    x = x + gb * _B_ref(h, B_w_gate, B_w_up, B_w_down)
    return x
```

```asm
; @launch kernel=ka_kernel grid=(256,1,1) block=(512,1,1) lds=13312
; @launch kernel=kb_kernel grid=(257,1,1) block=(256,1,1) lds=49152
; @launch kernel=kc_kernel grid=(256,1,1) block=(512,1,1) lds=133120
.amdgcn_target "amdgcn-amd-amdhsa--gfx950"
.text
.globl ka_kernel
.p2align 8
.type ka_kernel,@function
ka_kernel:
  s_cmp_ge_u32 s2, 256
  s_cbranch_scc1 ka_kernel_end
  s_load_dwordx2 s[32:33], s[0:1], 104
  v_lshrrev_b32 v1, 6, v0
  v_and_b32 v2, 63, v0
  v_readfirstlane_b32 s28, v1
  s_cmp_ge_u32 s2, 8
  s_cbranch_scc1 ka_kernel_nocpf
  s_getpc_b64 s[56:57]
ka_kernel_pc:
  s_add_u32 s56, s56, kb_kernel-ka_kernel_pc
  s_addc_u32 s57, s57, 0
  s_mov_b32 s58, code_end_label-kb_kernel
  v_lshlrev_b32 v100, 6, v0
  v_cmp_gt_u32 vcc, s58, v100
  s_and_saveexec_b64 s[40:41], vcc
  s_cbranch_execz ka_kernel_cpf0
  v_mov_b32 v103, s57
  v_add_co_u32 v102, vcc, s56, v100
  s_nop 1
  v_addc_co_u32 v103, vcc, 0, v103, vcc
  global_load_dword v104, v[102:103], off
ka_kernel_cpf0:
  s_mov_b64 exec, s[40:41]
  v_add_u32 v100, 0x8000, v100
  v_cmp_gt_u32 vcc, s58, v100
  s_and_saveexec_b64 s[40:41], vcc
  s_cbranch_execz ka_kernel_cpf1
  v_mov_b32 v103, s57
  v_add_co_u32 v102, vcc, s56, v100
  s_nop 1
  v_addc_co_u32 v103, vcc, 0, v103, vcc
  global_load_dword v105, v[102:103], off
ka_kernel_cpf1:
  s_mov_b64 exec, s[40:41]
ka_kernel_nocpf:
  s_load_dwordx2 s[4:5], s[0:1], 0
  s_load_dwordx2 s[6:7], s[0:1], 80
  s_load_dwordx2 s[42:43], s[0:1], 72
  v_and_b32 v3, 7, v2
  v_lshrrev_b32 v4, 3, v2
  v_lshlrev_b32 v5, 11, v3
  v_lshlrev_b32 v6, 3, v4
  v_add_u32 v5, v5, v6
  s_lshl_b32 s34, s28, 8
  v_add_u32 v5, s34, v5
  s_lshr_b32 s35, s2, 3
  s_and_b32 s36, s35, 3
  s_lshr_b32 s37, s35, 3
  s_and_b32 s37, s37, 1
  s_lshl_b32 s37, s37, 2
  s_or_b32 s36, s36, s37
  s_lshl_b32 s36, s36, 2
  s_and_b32 s37, s2, 7
  s_lshl_b32 s37, s37, 3
  s_add_u32 s36, s36, s37
  v_add_u32 v6, s36, v3
  v_and_b32 v6, 63, v6
  s_lshl_b32 s35, s35, 6
  v_add_u32 v6, s35, v6
  v_lshlrev_b32 v6, 3, v6
  v_lshlrev_b32 v7, 14, v4
  v_add_u32 v6, v6, v7
  s_lshl_b32 s38, s28, 19
  v_add_u32 v6, s38, v6
  v_lshlrev_b32 v12, 4, v2
  v_cmp_gt_u32 vcc, 48, v2
  v_bfrev_b32 v13, 1
  s_mul_i32 s39, s28, 98304
  v_add_u32 v12, s39, v12
  v_cndmask_b32 v12, v13, v12, vcc
  v_lshlrev_b32 v14, 1, v2
  s_waitcnt lgkmcnt(0)
  s_cmp_ge_u32 s2, 36
  s_cbranch_scc1 ka_kernel_noflg
  s_cmp_lg_u32 s28, 7
  s_cbranch_scc1 ka_kernel_noflg
  s_add_u32 s16, s32, 0x80000
  s_addc_u32 s17, s33, 0
  s_mov_b32 s18, 0x9000
  s_mov_b32 s19, 0x20000
  v_mov_b32 v112, 0
  v_mov_b32 v113, 0
  v_mov_b32 v114, 0
  v_mov_b32 v115, 0
  v_lshlrev_b32 v116, 4, v2
  s_lshl_b32 s34, s2, 10
  buffer_store_dwordx4 v[112:115], v116, s[16:19], s34 offen
ka_kernel_noflg:
  s_lshl_b32 s34, s2, 14
  s_add_u32 s8, s4, s34
  s_addc_u32 s9, s5, 0
  s_mov_b32 s10, 0x4000
  s_mov_b32 s11, 0x20000
  buffer_load_dwordx2 v[16:17], v5, s[8:11], 0 offen offset:0
  buffer_load_dwordx2 v[18:19], v5, s[8:11], 0 offen offset:64
  buffer_load_dwordx2 v[20:21], v5, s[8:11], 0 offen offset:128
  buffer_load_dwordx2 v[22:23], v5, s[8:11], 0 offen offset:192
  s_lshr_b32 s35, s2, 4
  s_and_b32 s36, s2, 15
  s_mul_i32 s37, s35, 786432
  s_mul_i32 s38, s36, 768
  s_add_u32 s37, s37, s38
  s_sub_u32 s38, 12582912, s37
  s_add_u32 s44, s6, s37
  s_addc_u32 s45, s7, 0
  s_mov_b32 s46, s38
  s_mov_b32 s47, 0x20000
  s_lshl_b32 s37, s35, 7
  s_lshl_b32 s38, s28, 4
  s_add_u32 s37, s37, s38
  s_add_u32 s48, s42, s37
  s_addc_u32 s49, s43, 0
  s_mov_b32 s50, 0x10
  s_mov_b32 s51, 0x20000
  buffer_load_ushort v15, v14, s[48:51], 0 offen
  s_mov_b32 s37, 0
  buffer_load_dwordx4 v[64:67], v12, s[44:47], s37 offen nt
  s_mov_b32 s37, 12288
  buffer_load_dwordx4 v[68:71], v12, s[44:47], s37 offen nt
  s_mov_b32 s37, 24576
  buffer_load_dwordx4 v[72:75], v12, s[44:47], s37 offen nt
  s_mov_b32 s37, 36864
  buffer_load_dwordx4 v[76:79], v12, s[44:47], s37 offen nt
  s_mov_b32 s37, 49152
  buffer_load_dwordx4 v[80:83], v12, s[44:47], s37 offen nt
  s_mov_b32 s37, 61440
  buffer_load_dwordx4 v[84:87], v12, s[44:47], s37 offen nt
  s_mov_b32 s37, 73728
  buffer_load_dwordx4 v[88:91], v12, s[44:47], s37 offen nt
  s_mov_b32 s37, 86016
  buffer_load_dwordx4 v[92:95], v12, s[44:47], s37 offen nt
  s_add_u32 s12, s32, 0x100000
  s_addc_u32 s13, s33, 0
  s_mov_b32 s14, 0x400000
  s_mov_b32 s15, 0x20000
  v_mov_b32 v8, 0
  v_mov_b32 v9, 0
  s_waitcnt vmcnt(12)
  v_lshlrev_b32 v32, 16, v16
  v_and_b32 v33, 0xffff0000, v16
  v_lshlrev_b32 v34, 16, v17
  v_and_b32 v35, 0xffff0000, v17
  v_add_f32 v8, v8, v32
  v_fma_f32 v9, v32, v32, v9
  v_add_f32 v8, v8, v33
  v_fma_f32 v9, v33, v33, v9
  v_add_f32 v8, v8, v34
  v_fma_f32 v9, v34, v34, v9
  v_add_f32 v8, v8, v35
  v_fma_f32 v9, v35, v35, v9
  s_waitcnt vmcnt(11)
  v_lshlrev_b32 v36, 16, v18
  v_and_b32 v37, 0xffff0000, v18
  v_lshlrev_b32 v38, 16, v19
  v_and_b32 v39, 0xffff0000, v19
  v_add_f32 v8, v8, v36
  v_fma_f32 v9, v36, v36, v9
  v_add_f32 v8, v8, v37
  v_fma_f32 v9, v37, v37, v9
  v_add_f32 v8, v8, v38
  v_fma_f32 v9, v38, v38, v9
  v_add_f32 v8, v8, v39
  v_fma_f32 v9, v39, v39, v9
  s_waitcnt vmcnt(10)
  v_lshlrev_b32 v40, 16, v20
  v_and_b32 v41, 0xffff0000, v20
  v_lshlrev_b32 v42, 16, v21
  v_and_b32 v43, 0xffff0000, v21
  v_add_f32 v8, v8, v40
  v_fma_f32 v9, v40, v40, v9
  v_add_f32 v8, v8, v41
  v_fma_f32 v9, v41, v41, v9
  v_add_f32 v8, v8, v42
  v_fma_f32 v9, v42, v42, v9
  v_add_f32 v8, v8, v43
  v_fma_f32 v9, v43, v43, v9
  s_waitcnt vmcnt(9)
  v_lshlrev_b32 v44, 16, v22
  v_and_b32 v45, 0xffff0000, v22
  v_lshlrev_b32 v46, 16, v23
  v_and_b32 v47, 0xffff0000, v23
  v_add_f32 v8, v8, v44
  v_fma_f32 v9, v44, v44, v9
  v_add_f32 v8, v8, v45
  v_fma_f32 v9, v45, v45, v9
  v_add_f32 v8, v8, v46
  v_fma_f32 v9, v46, v46, v9
  v_add_f32 v8, v8, v47
  v_fma_f32 v9, v47, v47, v9
  s_nop 1
  v_add_f32_dpp v8, v8, v8 row_ror:8 row_mask:0xf bank_mask:0xf
  v_add_f32_dpp v9, v9, v9 row_ror:8 row_mask:0xf bank_mask:0xf
  s_nop 1
  v_mov_b32 v10, v8
  v_mov_b32 v11, v9
  s_nop 1
  v_permlane16_swap_b32 v8, v10
  v_permlane16_swap_b32 v9, v11
  s_nop 1
  v_add_f32 v8, v8, v10
  v_add_f32 v9, v9, v11
  v_mov_b32 v10, v8
  v_mov_b32 v11, v9
  s_nop 1
  v_permlane32_swap_b32 v8, v10
  v_permlane32_swap_b32 v9, v11
  s_nop 1
  v_add_f32 v8, v8, v10
  v_add_f32 v9, v9, v11
  v_lshlrev_b32 v10, 6, v3
  s_lshl_b32 s34, s28, 3
  v_add_u32 v11, s34, v10
  v_cmp_gt_u32 vcc, 8, v2
  s_and_saveexec_b64 s[40:41], vcc
  ds_write_b64 v11, v[8:9]
  s_mov_b64 exec, s[40:41]
  s_waitcnt vmcnt(8)
  v_lshlrev_b32 v15, 16, v15
  v_mul_f32 v24, 0xbfb8aa3b, v15
  v_exp_f32 v24, v24
  s_nop 0
  v_add_f32 v24, 1.0, v24
  v_rcp_f32 v24, v24
  s_nop 0
  v_mul_f32 v15, v15, v24
  v_cvt_pk_bf16_f32 v15, v15, v15
  v_lshlrev_b32 v15, 16, v15
  s_waitcnt lgkmcnt(0)
  s_barrier
  ds_read_b128 v[48:51], v10 offset:0
  ds_read_b128 v[52:55], v10 offset:16
  ds_read_b128 v[56:59], v10 offset:32
  ds_read_b128 v[60:63], v10 offset:48
  v_readlane_b32 s52, v15, 0
  v_readlane_b32 s53, v15, 1
  v_readlane_b32 s54, v15, 2
  v_readlane_b32 s55, v15, 3
  v_readlane_b32 s56, v15, 4
  v_readlane_b32 s57, v15, 5
  v_readlane_b32 s58, v15, 6
  v_readlane_b32 s59, v15, 7
  s_waitcnt lgkmcnt(0)
  v_add_f32 v8, v48, v50
  v_add_f32 v9, v49, v51
  v_add_f32 v8, v8, v52
  v_add_f32 v9, v9, v53
  v_add_f32 v8, v8, v54
  v_add_f32 v9, v9, v55
  v_add_f32 v8, v8, v56
  v_add_f32 v9, v9, v57
  v_add_f32 v8, v8, v58
  v_add_f32 v9, v9, v59
  v_add_f32 v8, v8, v60
  v_add_f32 v9, v9, v61
  v_add_f32 v8, v8, v62
  v_add_f32 v9, v9, v63
  v_mul_f32 v8, 0x3a800000, v8
  v_mul_f32 v9, 0x3a800000, v9
  v_fma_f32 v9, -v8, v8, v9
  v_max_f32 v9, 0, v9
  v_add_f32 v9, 0x3727c5ac, v9
  v_rsq_f32 v9, v9
  s_nop 0
  v_mul_f32 v8, v8, v9
  v_fma_f32 v32, v32, v9, -v8
  v_fma_f32 v33, v33, v9, -v8
  v_fma_f32 v34, v34, v9, -v8
  v_fma_f32 v35, v35, v9, -v8
  v_fma_f32 v36, v36, v9, -v8
  v_fma_f32 v37, v37, v9, -v8
  v_fma_f32 v38, v38, v9, -v8
  v_fma_f32 v39, v39, v9, -v8
  v_fma_f32 v40, v40, v9, -v8
  v_fma_f32 v41, v41, v9, -v8
  v_fma_f32 v42, v42, v9, -v8
  v_fma_f32 v43, v43, v9, -v8
  v_fma_f32 v44, v44, v9, -v8
  v_fma_f32 v45, v45, v9, -v8
  v_fma_f32 v46, v46, v9, -v8
  v_fma_f32 v47, v47, v9, -v8
  v_cvt_pk_bf16_f32 v16, v32, v33
  v_cvt_pk_bf16_f32 v17, v34, v35
  v_cvt_pk_bf16_f32 v18, v36, v37
  v_cvt_pk_bf16_f32 v19, v38, v39
  v_cvt_pk_bf16_f32 v20, v40, v41
  v_cvt_pk_bf16_f32 v21, v42, v43
  v_cvt_pk_bf16_f32 v22, v44, v45
  v_cvt_pk_bf16_f32 v23, v46, v47
  s_mov_b32 s34, 0
  buffer_store_dwordx2 v[16:17], v6, s[12:15], s34 offen
  s_mov_b32 s34, 131072
  buffer_store_dwordx2 v[18:19], v6, s[12:15], s34 offen
  s_mov_b32 s34, 262144
  buffer_store_dwordx2 v[20:21], v6, s[12:15], s34 offen
  s_mov_b32 s34, 393216
  buffer_store_dwordx2 v[22:23], v6, s[12:15], s34 offen
  v_mov_b32 v32, 0
  v_mov_b32 v33, 0
  v_mov_b32 v34, 0
  v_mov_b32 v35, 0
  v_mov_b32 v36, 0
  v_mov_b32 v37, 0
  v_mov_b32 v38, 0
  v_mov_b32 v39, 0
  s_waitcnt vmcnt(11)
  v_lshlrev_b32 v8, 16, v64
  v_and_b32 v9, 0xffff0000, v64
  v_fma_f32 v32, v8, s52, v32
  v_fma_f32 v33, v9, s52, v33
  v_lshlrev_b32 v8, 16, v65
  v_and_b32 v9, 0xffff0000, v65
  v_fma_f32 v34, v8, s52, v34
  v_fma_f32 v35, v9, s52, v35
  v_lshlrev_b32 v8, 16, v66
  v_and_b32 v9, 0xffff0000, v66
  v_fma_f32 v36, v8, s52, v36
  v_fma_f32 v37, v9, s52, v37
  v_lshlrev_b32 v8, 16, v67
  v_and_b32 v9, 0xffff0000, v67
  v_fma_f32 v38, v8, s52, v38
  v_fma_f32 v39, v9, s52, v39
  s_waitcnt vmcnt(10)
  v_lshlrev_b32 v8, 16, v68
  v_and_b32 v9, 0xffff0000, v68
  v_fma_f32 v32, v8, s53, v32
  v_fma_f32 v33, v9, s53, v33
  v_lshlrev_b32 v8, 16, v69
  v_and_b32 v9, 0xffff0000, v69
  v_fma_f32 v34, v8, s53, v34
  v_fma_f32 v35, v9, s53, v35
  v_lshlrev_b32 v8, 16, v70
  v_and_b32 v9, 0xffff0000, v70
  v_fma_f32 v36, v8, s53, v36
  v_fma_f32 v37, v9, s53, v37
  v_lshlrev_b32 v8, 16, v71
  v_and_b32 v9, 0xffff0000, v71
  v_fma_f32 v38, v8, s53, v38
  v_fma_f32 v39, v9, s53, v39
  s_waitcnt vmcnt(9)
  v_lshlrev_b32 v8, 16, v72
  v_and_b32 v9, 0xffff0000, v72
  v_fma_f32 v32, v8, s54, v32
  v_fma_f32 v33, v9, s54, v33
  v_lshlrev_b32 v8, 16, v73
  v_and_b32 v9, 0xffff0000, v73
  v_fma_f32 v34, v8, s54, v34
  v_fma_f32 v35, v9, s54, v35
  v_lshlrev_b32 v8, 16, v74
  v_and_b32 v9, 0xffff0000, v74
  v_fma_f32 v36, v8, s54, v36
  v_fma_f32 v37, v9, s54, v37
  v_lshlrev_b32 v8, 16, v75
  v_and_b32 v9, 0xffff0000, v75
  v_fma_f32 v38, v8, s54, v38
  v_fma_f32 v39, v9, s54, v39
  s_waitcnt vmcnt(8)
  v_lshlrev_b32 v8, 16, v76
  v_and_b32 v9, 0xffff0000, v76
  v_fma_f32 v32, v8, s55, v32
  v_fma_f32 v33, v9, s55, v33
  v_lshlrev_b32 v8, 16, v77
  v_and_b32 v9, 0xffff0000, v77
  v_fma_f32 v34, v8, s55, v34
  v_fma_f32 v35, v9, s55, v35
  v_lshlrev_b32 v8, 16, v78
  v_and_b32 v9, 0xffff0000, v78
  v_fma_f32 v36, v8, s55, v36
  v_fma_f32 v37, v9, s55, v37
  v_lshlrev_b32 v8, 16, v79
  v_and_b32 v9, 0xffff0000, v79
  v_fma_f32 v38, v8, s55, v38
  v_fma_f32 v39, v9, s55, v39
  s_waitcnt vmcnt(7)
  v_lshlrev_b32 v8, 16, v80
  v_and_b32 v9, 0xffff0000, v80
  v_fma_f32 v32, v8, s56, v32
  v_fma_f32 v33, v9, s56, v33
  v_lshlrev_b32 v8, 16, v81
  v_and_b32 v9, 0xffff0000, v81
  v_fma_f32 v34, v8, s56, v34
  v_fma_f32 v35, v9, s56, v35
  v_lshlrev_b32 v8, 16, v82
  v_and_b32 v9, 0xffff0000, v82
  v_fma_f32 v36, v8, s56, v36
  v_fma_f32 v37, v9, s56, v37
  v_lshlrev_b32 v8, 16, v83
  v_and_b32 v9, 0xffff0000, v83
  v_fma_f32 v38, v8, s56, v38
  v_fma_f32 v39, v9, s56, v39
  s_waitcnt vmcnt(6)
  v_lshlrev_b32 v8, 16, v84
  v_and_b32 v9, 0xffff0000, v84
  v_fma_f32 v32, v8, s57, v32
  v_fma_f32 v33, v9, s57, v33
  v_lshlrev_b32 v8, 16, v85
  v_and_b32 v9, 0xffff0000, v85
  v_fma_f32 v34, v8, s57, v34
  v_fma_f32 v35, v9, s57, v35
  v_lshlrev_b32 v8, 16, v86
  v_and_b32 v9, 0xffff0000, v86
  v_fma_f32 v36, v8, s57, v36
  v_fma_f32 v37, v9, s57, v37
  v_lshlrev_b32 v8, 16, v87
  v_and_b32 v9, 0xffff0000, v87
  v_fma_f32 v38, v8, s57, v38
  v_fma_f32 v39, v9, s57, v39
  s_waitcnt vmcnt(5)
  v_lshlrev_b32 v8, 16, v88
  v_and_b32 v9, 0xffff0000, v88
  v_fma_f32 v32, v8, s58, v32
  v_fma_f32 v33, v9, s58, v33
  v_lshlrev_b32 v8, 16, v89
  v_and_b32 v9, 0xffff0000, v89
  v_fma_f32 v34, v8, s58, v34
  v_fma_f32 v35, v9, s58, v35
  v_lshlrev_b32 v8, 16, v90
  v_and_b32 v9, 0xffff0000, v90
  v_fma_f32 v36, v8, s58, v36
  v_fma_f32 v37, v9, s58, v37
  v_lshlrev_b32 v8, 16, v91
  v_and_b32 v9, 0xffff0000, v91
  v_fma_f32 v38, v8, s58, v38
  v_fma_f32 v39, v9, s58, v39
  s_waitcnt vmcnt(4)
  v_lshlrev_b32 v8, 16, v92
  v_and_b32 v9, 0xffff0000, v92
  v_fma_f32 v32, v8, s59, v32
  v_fma_f32 v33, v9, s59, v33
  v_lshlrev_b32 v8, 16, v93
  v_and_b32 v9, 0xffff0000, v93
  v_fma_f32 v34, v8, s59, v34
  v_fma_f32 v35, v9, s59, v35
  v_lshlrev_b32 v8, 16, v94
  v_and_b32 v9, 0xffff0000, v94
  v_fma_f32 v36, v8, s59, v36
  v_fma_f32 v37, v9, s59, v37
  v_lshlrev_b32 v8, 16, v95
  v_and_b32 v9, 0xffff0000, v95
  v_fma_f32 v38, v8, s59, v38
  v_fma_f32 v39, v9, s59, v39
  v_lshlrev_b32 v10, 5, v2
  s_mul_i32 s34, s28, 1536
  s_add_u32 s34, s34, 1024
  v_add_u32 v10, s34, v10
  v_cmp_gt_u32 vcc, 48, v2
  s_and_saveexec_b64 s[40:41], vcc
  ds_write_b128 v10, v[32:35]
  ds_write_b128 v10, v[36:39] offset:16
  s_mov_b64 exec, s[40:41]
  s_waitcnt lgkmcnt(0)
  s_barrier
  v_cmp_gt_u32 vcc, 384, v0
  s_and_saveexec_b64 s[40:41], vcc
  s_cbranch_execz ka_kernel_fin
  v_lshlrev_b32 v7, 2, v0
  ds_read_b32 v16, v7 offset:1024
  ds_read_b32 v17, v7 offset:2560
  ds_read_b32 v18, v7 offset:4096
  ds_read_b32 v19, v7 offset:5632
  ds_read_b32 v20, v7 offset:7168
  ds_read_b32 v21, v7 offset:8704
  ds_read_b32 v22, v7 offset:10240
  ds_read_b32 v23, v7 offset:11776
  s_waitcnt lgkmcnt(0)
  v_add_f32 v16, v16, v17
  v_add_f32 v18, v18, v19
  v_add_f32 v20, v20, v21
  v_add_f32 v22, v22, v23
  v_add_f32 v16, v16, v18
  v_add_f32 v20, v20, v22
  v_add_f32 v16, v16, v20
  s_mul_i32 s37, s35, 24576
  s_mul_i32 s38, s36, 1536
  s_add_u32 s37, s37, s38
  s_mov_b32 s12, s32
  s_mov_b32 s13, s33
  s_mov_b32 s14, 0x60000
  s_mov_b32 s15, 0x20000
  buffer_store_dword v16, v7, s[12:15], s37 offen
ka_kernel_fin:
  s_endpgm
ka_kernel_end:
  s_endpgm

.globl kb_kernel
.p2align 8
.type kb_kernel,@function
kb_kernel:
  s_cmp_ge_u32 s2, 257
  s_cbranch_scc1 kb_kernel_end
  s_cmp_eq_u32 s2, 256
  s_cbranch_scc1 kb_kernel_ctab
  s_load_dwordx2 s[32:33], s[0:1], 104
  s_load_dwordx2 s[4:5], s[0:1], 48
  v_mov_b32 v30, v0
  v_lshrrev_b32 v1, 6, v0
  v_and_b32 v0, 63, v0
  v_readfirstlane_b32 s28, v1
  s_and_b32 s34, s2, 7
  s_lshl_b32 s34, s34, 5
  s_lshr_b32 s35, s2, 3
  s_add_u32 s34, s34, s35
  v_lshlrev_b32 v2, 4, v0
  v_lshrrev_b32 v3, 4, v0
  v_and_b32 v4, 15, v0
  s_lshl_b32 s36, s28, 12
  v_add_u32 v5, s36, v2
  s_lshl_b32 s37, s34, 4
  v_lshrrev_b32 v6, 2, v0
  v_mul_u32_u24 v6, 24576, v6
  v_and_b32 v7, 3, v0
  v_lshl_add_u32 v6, v7, 2, v6
  v_add_u32 v6, s37, v6
  v_add_u32 v7, 4096, v6
  s_mul_i32 s37, s2, 24
  s_mul_i32 s38, s28, 6
  s_add_u32 s37, s37, s38
  v_add_u32 v16, s37, v3
  v_mul_u32_u24 v17, 24576, v4
  v_lshl_add_u32 v17, v16, 2, v17
  s_waitcnt lgkmcnt(0)
  s_lshl_b32 s35, s34, 14
  s_add_u32 s8, s32, s35
  s_addc_u32 s9, s33, 0
  s_add_u32 s8, s8, 0x100000
  s_addc_u32 s9, s9, 0
  s_mov_b32 s10, 0x4000
  s_mov_b32 s11, 0x20000
  s_mov_b32 m0, s36
  s_add_u32 s56, s32, 0x60000
  s_addc_u32 s57, s33, 0
  s_mov_b32 s58, 0x8000
  s_mov_b32 s59, 0x20000
  buffer_load_dwordx4 v5, s[8:11], 0 offen offset:0 lds
  buffer_load_dwordx4 v5, s[8:11], 0 offen offset:1024 lds
  buffer_load_dwordx4 v5, s[8:11], 0 offen offset:2048 lds
  buffer_load_dwordx4 v5, s[8:11], 0 offen offset:3072 lds
  s_mov_b32 s12, s32
  s_mov_b32 s13, s33
  s_mov_b32 s14, 0x60000
  s_mov_b32 s15, 0x20000
  buffer_load_dword v8, v6, s[12:15], 0 offen
  buffer_load_dword v12, v7, s[12:15], 0 offen
  buffer_load_dword v20, v17, s[12:15], 0 offen
  buffer_load_dword v21, v17, s[12:15], 0 offen offset:16
  s_mul_i32 s35, s34, 16384
  s_add_u32 s16, s32, s35
  s_addc_u32 s17, s33, 0
  s_add_u32 s16, s16, 0x500000
  s_addc_u32 s17, s17, 0
  s_mov_b32 s18, 0x4000
  s_mov_b32 s19, 0x20000
  v_bfe_u32 v25, v0, 2, 2
  v_and_b32 v26, 3, v0
  v_lshlrev_b32 v27, 12, v3
  v_lshlrev_b32 v28, 9, v25
  v_add_u32 v27, v27, v28
  v_lshlrev_b32 v28, 2, v25
  v_add_u32 v28, v28, v26
  v_and_b32 v29, 1, v3
  v_lshlrev_b32 v29, 4, v29
  v_add_u32 v28, v28, v29
  s_lshl_b32 s36, s28, 4
  v_add_u32 v28, s36, v28
  v_add_u32 v29, 0, v28
  v_and_b32 v29, 63, v29
  v_lshl_add_u32 v88, v29, 3, v27
  v_add_u32 v29, 4, v28
  v_and_b32 v29, 63, v29
  v_lshl_add_u32 v89, v29, 3, v27
  v_add_u32 v29, 8, v28
  v_and_b32 v29, 63, v29
  v_lshl_add_u32 v90, v29, 3, v27
  v_add_u32 v29, 12, v28
  v_and_b32 v29, 63, v29
  v_lshl_add_u32 v91, v29, 3, v27
  s_lshr_b32 s36, s28, 1
  s_lshl_b32 s36, s36, 10
  s_and_b32 s37, s28, 1
  s_lshl_b32 s37, s37, 3
  s_add_u32 s36, s36, s37
  s_add_u32 s36, s36, 16384
  v_add_u32 v92, s36, v2
  s_and_b32 s36, s28, 1
  s_lshl_b32 s36, s36, 12
  s_add_u32 s36, s36, 16384
  v_add_u32 v93, s36, v2
  s_and_b32 s36, s28, 1
  s_lshl_b32 s36, s36, 4
  s_lshr_b32 s37, s28, 1
  s_lshl_b32 s37, s37, 9
  s_add_u32 s36, s36, s37
  v_lshlrev_b32 v94, 7, v3
  v_add_u32 v94, v94, v4
  v_add_u32 v94, s36, v94
  v_lshlrev_b32 v94, 4, v94
  v_and_b32 v25, 1, v3
  v_lshlrev_b32 v25, 31, v25
  v_lshrrev_b32 v26, 16, v25
  v_or_b32 v25, v25, v26
  v_or_b32 v25, 0x3f803f80, v25
  v_cmp_eq_u32 vcc, 0, v4
  s_nop 1
  v_cndmask_b32 v25, 0, v25, vcc
  v_mov_b32 v240, v25
  v_mov_b32 v241, v25
  v_mov_b32 v242, v25
  v_mov_b32 v243, v25
  v_lshlrev_b32 v24, 3, v3
  v_mul_u32_u24 v24, v24, v4
  v_and_b32 v25, 31, v24
  v_cvt_f32_u32 v108, v25
  v_mul_f32 v108, 0x3d000000, v108
  v_cos_f32 v100, v108
  v_sin_f32 v108, v108
  v_add_u32 v24, v24, v4
  v_and_b32 v25, 31, v24
  v_cvt_f32_u32 v109, v25
  v_mul_f32 v109, 0x3d000000, v109
  v_cos_f32 v101, v109
  v_sin_f32 v109, v109
  v_add_u32 v24, v24, v4
  v_and_b32 v25, 31, v24
  v_cvt_f32_u32 v110, v25
  v_mul_f32 v110, 0x3d000000, v110
  v_cos_f32 v102, v110
  v_sin_f32 v110, v110
  v_add_u32 v24, v24, v4
  v_and_b32 v25, 31, v24
  v_cvt_f32_u32 v111, v25
  v_mul_f32 v111, 0x3d000000, v111
  v_cos_f32 v103, v111
  v_sin_f32 v111, v111
  v_add_u32 v24, v24, v4
  v_and_b32 v25, 31, v24
  v_cvt_f32_u32 v112, v25
  v_mul_f32 v112, 0x3d000000, v112
  v_cos_f32 v104, v112
  v_sin_f32 v112, v112
  v_add_u32 v24, v24, v4
  v_and_b32 v25, 31, v24
  v_cvt_f32_u32 v113, v25
  v_mul_f32 v113, 0x3d000000, v113
  v_cos_f32 v105, v113
  v_sin_f32 v113, v113
  v_add_u32 v24, v24, v4
  v_and_b32 v25, 31, v24
  v_cvt_f32_u32 v114, v25
  v_mul_f32 v114, 0x3d000000, v114
  v_cos_f32 v106, v114
  v_sin_f32 v114, v114
  v_add_u32 v24, v24, v4
  v_and_b32 v25, 31, v24
  v_cvt_f32_u32 v115, v25
  v_mul_f32 v115, 0x3d000000, v115
  v_cos_f32 v107, v115
  v_sin_f32 v115, v115
  s_nop 0
  v_cvt_pk_bf16_f32 v32, v100, v101
  v_cvt_pk_bf16_f32 v40, -v108, -v109
  v_cvt_pk_bf16_f32 v33, v102, v103
  v_cvt_pk_bf16_f32 v41, -v110, -v111
  v_cvt_pk_bf16_f32 v34, v104, v105
  v_cvt_pk_bf16_f32 v42, -v112, -v113
  v_cvt_pk_bf16_f32 v35, v106, v107
  v_cvt_pk_bf16_f32 v43, -v114, -v115
  v_xor_b32 v36, 0x80000000, v32
  v_xor_b32 v44, 0x80000000, v40
  v_xor_b32 v37, 0x80000000, v33
  v_xor_b32 v45, 0x80000000, v41
  v_xor_b32 v38, 0x80000000, v34
  v_xor_b32 v46, 0x80000000, v42
  v_xor_b32 v39, 0x80000000, v35
  v_xor_b32 v47, 0x80000000, v43
  s_lshr_b32 s36, s28, 1
  s_lshl_b32 s36, s36, 4
  v_add_u32 v26, s36, v4
  v_add_u32 v25, 0, v3
  v_mul_u32_u24 v25, v25, v26
  v_and_b32 v25, 63, v25
  v_cvt_f32_u32 v108, v25
  v_mul_f32 v108, 0x3c800000, v108
  v_cos_f32 v100, v108
  v_sin_f32 v108, v108
  v_add_u32 v25, 4, v3
  v_mul_u32_u24 v25, v25, v26
  v_and_b32 v25, 63, v25
  v_cvt_f32_u32 v109, v25
  v_mul_f32 v109, 0x3c800000, v109
  v_cos_f32 v101, v109
  v_sin_f32 v109, v109
  v_add_u32 v25, 8, v3
  v_mul_u32_u24 v25, v25, v26
  v_and_b32 v25, 63, v25
  v_cvt_f32_u32 v110, v25
  v_mul_f32 v110, 0x3c800000, v110
  v_cos_f32 v102, v110
  v_sin_f32 v110, v110
  v_add_u32 v25, 12, v3
  v_mul_u32_u24 v25, v25, v26
  v_and_b32 v25, 63, v25
  v_cvt_f32_u32 v111, v25
  v_mul_f32 v111, 0x3c800000, v111
  v_cos_f32 v103, v111
  v_sin_f32 v111, v111
  v_add_u32 v25, 16, v3
  v_mul_u32_u24 v25, v25, v26
  v_and_b32 v25, 63, v25
  v_cvt_f32_u32 v112, v25
  v_mul_f32 v112, 0x3c800000, v112
  v_cos_f32 v104, v112
  v_sin_f32 v112, v112
  v_add_u32 v25, 20, v3
  v_mul_u32_u24 v25, v25, v26
  v_and_b32 v25, 63, v25
  v_cvt_f32_u32 v113, v25
  v_mul_f32 v113, 0x3c800000, v113
  v_cos_f32 v105, v113
  v_sin_f32 v113, v113
  v_add_u32 v25, 24, v3
  v_mul_u32_u24 v25, v25, v26
  v_and_b32 v25, 63, v25
  v_cvt_f32_u32 v114, v25
  v_mul_f32 v114, 0x3c800000, v114
  v_cos_f32 v106, v114
  v_sin_f32 v114, v114
  v_add_u32 v25, 28, v3
  v_mul_u32_u24 v25, v25, v26
  v_and_b32 v25, 63, v25
  v_cvt_f32_u32 v115, v25
  v_mul_f32 v115, 0x3c800000, v115
  v_cos_f32 v107, v115
  v_sin_f32 v115, v115
  v_and_b32 v25, 1, v26
  v_sub_u32 v27, 0, v25
  v_and_b32 v27, 0x80008000, v27
  v_cvt_pk_bf16_f32 v48, v100, v101
  v_cvt_pk_bf16_f32 v56, v108, v109
  v_cvt_pk_bf16_f32 v49, v102, v103
  v_cvt_pk_bf16_f32 v57, v110, v111
  v_cvt_pk_bf16_f32 v50, v104, v105
  v_cvt_pk_bf16_f32 v58, v112, v113
  v_cvt_pk_bf16_f32 v51, v106, v107
  v_cvt_pk_bf16_f32 v59, v114, v115
  v_xor_b32 v52, v27, v48
  v_xor_b32 v60, v27, v56
  v_xor_b32 v53, v27, v49
  v_xor_b32 v61, v27, v57
  v_xor_b32 v54, v27, v50
  v_xor_b32 v62, v27, v58
  v_xor_b32 v55, v27, v51
  v_xor_b32 v63, v27, v59
  v_xor_b32 v64, 0x80008000, v56
  v_xor_b32 v65, 0x80008000, v57
  v_xor_b32 v66, 0x80008000, v58
  v_xor_b32 v67, 0x80008000, v59
  v_xor_b32 v68, 0x80008000, v60
  v_xor_b32 v69, 0x80008000, v61
  v_xor_b32 v70, 0x80008000, v62
  v_xor_b32 v71, 0x80008000, v63
  s_lshl_b32 s36, s28, 4
  v_add_u32 v25, s36, v3
  v_add_u32 v27, 0, v4
  v_mul_u32_u24 v27, v25, v27
  v_cvt_f32_u32 v73, v27
  v_mul_f32 v73, 0x3a000000, v73
  v_cos_f32 v72, v73
  v_sin_f32 v73, v73
  v_add_u32 v27, 16, v4
  v_mul_u32_u24 v27, v25, v27
  v_cvt_f32_u32 v75, v27
  v_mul_f32 v75, 0x3a000000, v75
  v_cos_f32 v74, v75
  v_sin_f32 v75, v75
  v_add_u32 v25, s36, v3
  v_add_u32 v25, 4, v25
  v_add_u32 v27, 0, v4
  v_mul_u32_u24 v27, v25, v27
  v_cvt_f32_u32 v77, v27
  v_mul_f32 v77, 0x3a000000, v77
  v_cos_f32 v76, v77
  v_sin_f32 v77, v77
  v_add_u32 v27, 16, v4
  v_mul_u32_u24 v27, v25, v27
  v_cvt_f32_u32 v79, v27
  v_mul_f32 v79, 0x3a000000, v79
  v_cos_f32 v78, v79
  v_sin_f32 v79, v79
  v_add_u32 v25, s36, v3
  v_add_u32 v25, 8, v25
  v_add_u32 v27, 0, v4
  v_mul_u32_u24 v27, v25, v27
  v_cvt_f32_u32 v81, v27
  v_mul_f32 v81, 0x3a000000, v81
  v_cos_f32 v80, v81
  v_sin_f32 v81, v81
  v_add_u32 v27, 16, v4
  v_mul_u32_u24 v27, v25, v27
  v_cvt_f32_u32 v83, v27
  v_mul_f32 v83, 0x3a000000, v83
  v_cos_f32 v82, v83
  v_sin_f32 v83, v83
  v_add_u32 v25, s36, v3
  v_add_u32 v25, 12, v25
  v_add_u32 v27, 0, v4
  v_mul_u32_u24 v27, v25, v27
  v_cvt_f32_u32 v85, v27
  v_mul_f32 v85, 0x3a000000, v85
  v_cos_f32 v84, v85
  v_sin_f32 v85, v85
  v_add_u32 v27, 16, v4
  v_mul_u32_u24 v27, v25, v27
  v_cvt_f32_u32 v87, v27
  v_mul_f32 v87, 0x3a000000, v87
  v_cos_f32 v86, v87
  v_sin_f32 v87, v87
  s_waitcnt vmcnt(0)
  s_barrier
  s_cmp_ge_u32 s2, 8
  s_cbranch_scc1 kb_kernel_nocpa
  s_getpc_b64 s[60:61]
kb_kernel_pcca:
  s_add_u32 s60, s60, kc_kernel-kb_kernel_pcca
  s_addc_u32 s61, s61, 0
  s_mov_b32 s62, code_end_label-kc_kernel
  v_lshlrev_b32 v116, 6, v30
  v_cmp_gt_u32 vcc, s62, v116
  s_and_saveexec_b64 s[64:65], vcc
  s_cbranch_execz kb_kernel_cpxa
  v_mov_b32 v119, s61
  v_add_co_u32 v118, vcc, s60, v116
  s_nop 1
  v_addc_co_u32 v119, vcc, 0, v119, vcc
  global_load_dword v117, v[118:119], off
kb_kernel_cpxa:
  s_mov_b64 exec, s[64:65]
kb_kernel_nocpa:
  s_mov_b32 s24, s4
  s_mov_b32 s25, s5
  s_mov_b32 s26, 0x700000
  s_mov_b32 s27, 0x20000
  s_lshl_b32 s37, s2, 8
  v_add_u32 v31, s37, v30
  v_lshlrev_b32 v31, 6, v31
  s_mov_b32 s37, 0
  buffer_load_dword v96, v31, s[24:27], s37 offen
  s_mov_b32 s37, 4194304
  buffer_load_dword v97, v31, s[24:27], s37 offen
  ds_read_b64_tr_b16 v[100:101], v88 offset:0
  ds_read_b64_tr_b16 v[102:103], v88 offset:2048
  ds_read_b64_tr_b16 v[104:105], v89 offset:0
  ds_read_b64_tr_b16 v[106:107], v89 offset:2048
  ds_read_b64_tr_b16 v[108:109], v90 offset:0
  ds_read_b64_tr_b16 v[110:111], v90 offset:2048
  ds_read_b64_tr_b16 v[112:113], v91 offset:0
  ds_read_b64_tr_b16 v[114:115], v91 offset:2048
  s_waitcnt lgkmcnt(6)
  v_mfma_f32_16x16x32_bf16 v[128:131], v[100:103], v[32:35], 0
  v_mfma_f32_16x16x32_bf16 v[132:135], v[100:103], v[40:43], 0
  v_mfma_f32_16x16x32_bf16 v[136:139], v[100:103], v[36:39], 0
  v_mfma_f32_16x16x32_bf16 v[140:143], v[100:103], v[44:47], 0
  s_waitcnt lgkmcnt(4)
  v_mfma_f32_16x16x32_bf16 v[144:147], v[104:107], v[32:35], 0
  v_mfma_f32_16x16x32_bf16 v[148:151], v[104:107], v[40:43], 0
  v_mfma_f32_16x16x32_bf16 v[152:155], v[104:107], v[36:39], 0
  v_mfma_f32_16x16x32_bf16 v[156:159], v[104:107], v[44:47], 0
  s_waitcnt lgkmcnt(2)
  v_mfma_f32_16x16x32_bf16 v[160:163], v[108:111], v[32:35], 0
  v_mfma_f32_16x16x32_bf16 v[164:167], v[108:111], v[40:43], 0
  v_mfma_f32_16x16x32_bf16 v[168:171], v[108:111], v[36:39], 0
  v_mfma_f32_16x16x32_bf16 v[172:175], v[108:111], v[44:47], 0
  s_waitcnt lgkmcnt(0)
  v_mfma_f32_16x16x32_bf16 v[176:179], v[112:115], v[32:35], 0
  v_mfma_f32_16x16x32_bf16 v[180:183], v[112:115], v[40:43], 0
  v_mfma_f32_16x16x32_bf16 v[184:187], v[112:115], v[36:39], 0
  v_mfma_f32_16x16x32_bf16 v[188:191], v[112:115], v[44:47], 0
  s_nop 1
  v_add_f32_dpp v8, v8, v8 row_ror:4 row_mask:0xf bank_mask:0xf
  v_add_f32_dpp v12, v12, v12 row_ror:4 row_mask:0xf bank_mask:0xf
  s_nop 1
  v_add_f32_dpp v8, v8, v8 row_ror:8 row_mask:0xf bank_mask:0xf
  v_add_f32_dpp v12, v12, v12 row_ror:8 row_mask:0xf bank_mask:0xf
  s_nop 1
  v_mov_b32 v9, v8
  v_mov_b32 v13, v12
  s_nop 1
  v_permlane16_swap_b32 v8, v9
  v_permlane16_swap_b32 v12, v13
  s_nop 1
  v_add_f32 v8, v8, v9
  v_add_f32 v12, v12, v13
  v_mov_b32 v9, v8
  v_mov_b32 v13, v12
  s_nop 1
  v_permlane32_swap_b32 v8, v9
  v_permlane32_swap_b32 v12, v13
  s_nop 1
  v_add_f32 v8, v8, v9
  v_add_f32 v12, v12, v13
  v_cvt_pk_bf16_f32 v8, v8, v8
  v_lshlrev_b32 v8, 16, v8
  v_cvt_pk_bf16_f32 v12, v12, v12
  v_lshlrev_b32 v12, 16, v12
  v_add_f32 v13, 1.0, v12
  v_cvt_pk_bf16_f32 v13, v13, v13
  v_lshlrev_b32 v13, 16, v13
  v_mul_f32 v8, 0x45000000, v8
  v_pk_mul_f32 v[192:193], v[128:129], v[72:73] op_sel:[0,0] op_sel_hi:[1,0]
  v_pk_mul_f32 v[224:225], v[132:133], v[72:73] op_sel:[0,0] op_sel_hi:[1,0]
  v_pk_mul_f32 v[194:195], v[130:131], v[72:73] op_sel:[0,0] op_sel_hi:[1,0]
  v_pk_mul_f32 v[226:227], v[134:135], v[72:73] op_sel:[0,0] op_sel_hi:[1,0]
  v_pk_fma_f32 v[192:193], v[132:133], v[72:73], v[192:193] op_sel:[0,1,0] op_sel_hi:[1,1,1]
  v_pk_fma_f32 v[132:133], v[128:129], v[72:73], v[224:225] op_sel:[0,1,0] op_sel_hi:[1,1,1] neg_lo:[1,0,0] neg_hi:[1,0,0]
  v_pk_fma_f32 v[194:195], v[134:135], v[72:73], v[194:195] op_sel:[0,1,0] op_sel_hi:[1,1,1]
  v_pk_fma_f32 v[134:135], v[130:131], v[72:73], v[226:227] op_sel:[0,1,0] op_sel_hi:[1,1,1] neg_lo:[1,0,0] neg_hi:[1,0,0]
  v_pk_mul_f32 v[196:197], v[136:137], v[74:75] op_sel:[0,0] op_sel_hi:[1,0]
  v_pk_mul_f32 v[224:225], v[140:141], v[74:75] op_sel:[0,0] op_sel_hi:[1,0]
  v_pk_mul_f32 v[198:199], v[138:139], v[74:75] op_sel:[0,0] op_sel_hi:[1,0]
  v_pk_mul_f32 v[226:227], v[142:143], v[74:75] op_sel:[0,0] op_sel_hi:[1,0]
  v_pk_fma_f32 v[196:197], v[140:141], v[74:75], v[196:197] op_sel:[0,1,0] op_sel_hi:[1,1,1]
  v_pk_fma_f32 v[140:141], v[136:137], v[74:75], v[224:225] op_sel:[0,1,0] op_sel_hi:[1,1,1] neg_lo:[1,0,0] neg_hi:[1,0,0]
  v_pk_fma_f32 v[198:199], v[142:143], v[74:75], v[198:199] op_sel:[0,1,0] op_sel_hi:[1,1,1]
  v_pk_fma_f32 v[142:143], v[138:139], v[74:75], v[226:227] op_sel:[0,1,0] op_sel_hi:[1,1,1] neg_lo:[1,0,0] neg_hi:[1,0,0]
  v_pk_mul_f32 v[200:201], v[144:145], v[76:77] op_sel:[0,0] op_sel_hi:[1,0]
  v_pk_mul_f32 v[224:225], v[148:149], v[76:77] op_sel:[0,0] op_sel_hi:[1,0]
  v_pk_mul_f32 v[202:203], v[146:147], v[76:77] op_sel:[0,0] op_sel_hi:[1,0]
  v_pk_mul_f32 v[226:227], v[150:151], v[76:77] op_sel:[0,0] op_sel_hi:[1,0]
  v_pk_fma_f32 v[200:201], v[148:149], v[76:77], v[200:201] op_sel:[0,1,0] op_sel_hi:[1,1,1]
  v_pk_fma_f32 v[148:149], v[144:145], v[76:77], v[224:225] op_sel:[0,1,0] op_sel_hi:[1,1,1] neg_lo:[1,0,0] neg_hi:[1,0,0]
  v_pk_fma_f32 v[202:203], v[150:151], v[76:77], v[202:203] op_sel:[0,1,0] op_sel_hi:[1,1,1]
  v_pk_fma_f32 v[150:151], v[146:147], v[76:77], v[226:227] op_sel:[0,1,0] op_sel_hi:[1,1,1] neg_lo:[1,0,0] neg_hi:[1,0,0]
  v_pk_mul_f32 v[204:205], v[152:153], v[78:79] op_sel:[0,0] op_sel_hi:[1,0]
  v_pk_mul_f32 v[224:225], v[156:157], v[78:79] op_sel:[0,0] op_sel_hi:[1,0]
  v_pk_mul_f32 v[206:207], v[154:155], v[78:79] op_sel:[0,0] op_sel_hi:[1,0]
  v_pk_mul_f32 v[226:227], v[158:159], v[78:79] op_sel:[0,0] op_sel_hi:[1,0]
  v_pk_fma_f32 v[204:205], v[156:157], v[78:79], v[204:205] op_sel:[0,1,0] op_sel_hi:[1,1,1]
  v_pk_fma_f32 v[156:157], v[152:153], v[78:79], v[224:225] op_sel:[0,1,0] op_sel_hi:[1,1,1] neg_lo:[1,0,0] neg_hi:[1,0,0]
  v_pk_fma_f32 v[206:207], v[158:159], v[78:79], v[206:207] op_sel:[0,1,0] op_sel_hi:[1,1,1]
  v_pk_fma_f32 v[158:159], v[154:155], v[78:79], v[226:227] op_sel:[0,1,0] op_sel_hi:[1,1,1] neg_lo:[1,0,0] neg_hi:[1,0,0]
  v_pk_mul_f32 v[208:209], v[160:161], v[80:81] op_sel:[0,0] op_sel_hi:[1,0]
  v_pk_mul_f32 v[224:225], v[164:165], v[80:81] op_sel:[0,0] op_sel_hi:[1,0]
  v_pk_mul_f32 v[210:211], v[162:163], v[80:81] op_sel:[0,0] op_sel_hi:[1,0]
  v_pk_mul_f32 v[226:227], v[166:167], v[80:81] op_sel:[0,0] op_sel_hi:[1,0]
  v_pk_fma_f32 v[208:209], v[164:165], v[80:81], v[208:209] op_sel:[0,1,0] op_sel_hi:[1,1,1]
  v_pk_fma_f32 v[164:165], v[160:161], v[80:81], v[224:225] op_sel:[0,1,0] op_sel_hi:[1,1,1] neg_lo:[1,0,0] neg_hi:[1,0,0]
  v_pk_fma_f32 v[210:211], v[166:167], v[80:81], v[210:211] op_sel:[0,1,0] op_sel_hi:[1,1,1]
  v_pk_fma_f32 v[166:167], v[162:163], v[80:81], v[226:227] op_sel:[0,1,0] op_sel_hi:[1,1,1] neg_lo:[1,0,0] neg_hi:[1,0,0]
  v_pk_mul_f32 v[212:213], v[168:169], v[82:83] op_sel:[0,0] op_sel_hi:[1,0]
  v_pk_mul_f32 v[224:225], v[172:173], v[82:83] op_sel:[0,0] op_sel_hi:[1,0]
  v_pk_mul_f32 v[214:215], v[170:171], v[82:83] op_sel:[0,0] op_sel_hi:[1,0]
  v_pk_mul_f32 v[226:227], v[174:175], v[82:83] op_sel:[0,0] op_sel_hi:[1,0]
  v_pk_fma_f32 v[212:213], v[172:173], v[82:83], v[212:213] op_sel:[0,1,0] op_sel_hi:[1,1,1]
  v_pk_fma_f32 v[172:173], v[168:169], v[82:83], v[224:225] op_sel:[0,1,0] op_sel_hi:[1,1,1] neg_lo:[1,0,0] neg_hi:[1,0,0]
  v_pk_fma_f32 v[214:215], v[174:175], v[82:83], v[214:215] op_sel:[0,1,0] op_sel_hi:[1,1,1]
  v_pk_fma_f32 v[174:175], v[170:171], v[82:83], v[226:227] op_sel:[0,1,0] op_sel_hi:[1,1,1] neg_lo:[1,0,0] neg_hi:[1,0,0]
  v_pk_mul_f32 v[216:217], v[176:177], v[84:85] op_sel:[0,0] op_sel_hi:[1,0]
  v_pk_mul_f32 v[224:225], v[180:181], v[84:85] op_sel:[0,0] op_sel_hi:[1,0]
  v_pk_mul_f32 v[218:219], v[178:179], v[84:85] op_sel:[0,0] op_sel_hi:[1,0]
  v_pk_mul_f32 v[226:227], v[182:183], v[84:85] op_sel:[0,0] op_sel_hi:[1,0]
  v_pk_fma_f32 v[216:217], v[180:181], v[84:85], v[216:217] op_sel:[0,1,0] op_sel_hi:[1,1,1]
  v_pk_fma_f32 v[180:181], v[176:177], v[84:85], v[224:225] op_sel:[0,1,0] op_sel_hi:[1,1,1] neg_lo:[1,0,0] neg_hi:[1,0,0]
  v_pk_fma_f32 v[218:219], v[182:183], v[84:85], v[218:219] op_sel:[0,1,0] op_sel_hi:[1,1,1]
  v_pk_fma_f32 v[182:183], v[178:179], v[84:85], v[226:227] op_sel:[0,1,0] op_sel_hi:[1,1,1] neg_lo:[1,0,0] neg_hi:[1,0,0]
  v_pk_mul_f32 v[220:221], v[184:185], v[86:87] op_sel:[0,0] op_sel_hi:[1,0]
  v_pk_mul_f32 v[224:225], v[188:189], v[86:87] op_sel:[0,0] op_sel_hi:[1,0]
  v_pk_mul_f32 v[222:223], v[186:187], v[86:87] op_sel:[0,0] op_sel_hi:[1,0]
  v_pk_mul_f32 v[226:227], v[190:191], v[86:87] op_sel:[0,0] op_sel_hi:[1,0]
  v_pk_fma_f32 v[220:221], v[188:189], v[86:87], v[220:221] op_sel:[0,1,0] op_sel_hi:[1,1,1]
  v_pk_fma_f32 v[188:189], v[184:185], v[86:87], v[224:225] op_sel:[0,1,0] op_sel_hi:[1,1,1] neg_lo:[1,0,0] neg_hi:[1,0,0]
  v_pk_fma_f32 v[222:223], v[190:191], v[86:87], v[222:223] op_sel:[0,1,0] op_sel_hi:[1,1,1]
  v_pk_fma_f32 v[190:191], v[186:187], v[86:87], v[226:227] op_sel:[0,1,0] op_sel_hi:[1,1,1] neg_lo:[1,0,0] neg_hi:[1,0,0]
  v_readlane_b32 s44, v13, 0
  v_readlane_b32 s48, v8, 0
  v_readlane_b32 s45, v13, 1
  v_readlane_b32 s49, v8, 1
  v_readlane_b32 s46, v13, 2
  v_readlane_b32 s50, v8, 2
  v_readlane_b32 s47, v13, 3
  v_readlane_b32 s51, v8, 3
  v_cvt_pk_bf16_f32 v100, v192, v200
  v_cvt_pk_bf16_f32 v101, v208, v216
  ds_write_b64 v92, v[100:101] offset:0
  v_cvt_pk_bf16_f32 v102, v132, v148
  v_cvt_pk_bf16_f32 v103, v164, v180
  ds_write_b64 v92, v[102:103] offset:2048
  v_cvt_pk_bf16_f32 v104, v196, v204
  v_cvt_pk_bf16_f32 v105, v212, v220
  ds_write_b64 v92, v[104:105] offset:4096
  v_cvt_pk_bf16_f32 v106, v140, v156
  v_cvt_pk_bf16_f32 v107, v172, v188
  ds_write_b64 v92, v[106:107] offset:6144
  v_cvt_pk_bf16_f32 v108, v193, v201
  v_cvt_pk_bf16_f32 v109, v209, v217
  ds_write_b64 v92, v[108:109] offset:8192
  v_cvt_pk_bf16_f32 v110, v133, v149
  v_cvt_pk_bf16_f32 v111, v165, v181
  ds_write_b64 v92, v[110:111] offset:10240
  v_cvt_pk_bf16_f32 v112, v197, v205
  v_cvt_pk_bf16_f32 v113, v213, v221
  ds_write_b64 v92, v[112:113] offset:12288
  v_cvt_pk_bf16_f32 v114, v141, v157
  v_cvt_pk_bf16_f32 v115, v173, v189
  ds_write_b64 v92, v[114:115] offset:14336
  v_cvt_pk_bf16_f32 v100, v194, v202
  v_cvt_pk_bf16_f32 v101, v210, v218
  ds_write_b64 v92, v[100:101] offset:16384
  v_cvt_pk_bf16_f32 v102, v134, v150
  v_cvt_pk_bf16_f32 v103, v166, v182
  ds_write_b64 v92, v[102:103] offset:18432
  v_cvt_pk_bf16_f32 v104, v198, v206
  v_cvt_pk_bf16_f32 v105, v214, v222
  ds_write_b64 v92, v[104:105] offset:20480
  v_cvt_pk_bf16_f32 v106, v142, v158
  v_cvt_pk_bf16_f32 v107, v174, v190
  ds_write_b64 v92, v[106:107] offset:22528
  v_cvt_pk_bf16_f32 v108, v195, v203
  v_cvt_pk_bf16_f32 v109, v211, v219
  ds_write_b64 v92, v[108:109] offset:24576
  v_cvt_pk_bf16_f32 v110, v135, v151
  v_cvt_pk_bf16_f32 v111, v167, v183
  ds_write_b64 v92, v[110:111] offset:26624
  v_cvt_pk_bf16_f32 v112, v199, v207
  v_cvt_pk_bf16_f32 v113, v215, v223
  ds_write_b64 v92, v[112:113] offset:28672
  v_cvt_pk_bf16_f32 v114, v143, v159
  v_cvt_pk_bf16_f32 v115, v175, v191
  ds_write_b64 v92, v[114:115] offset:30720
  s_waitcnt lgkmcnt(0)
  s_barrier
  ds_read_b128 v[128:131], v93 offset:0
  ds_read_b128 v[132:135], v93 offset:1024
  ds_read_b128 v[136:139], v93 offset:2048
  ds_read_b128 v[140:143], v93 offset:3072
  ds_read_b128 v[144:147], v93 offset:8192
  ds_read_b128 v[148:151], v93 offset:9216
  ds_read_b128 v[152:155], v93 offset:10240
  ds_read_b128 v[156:159], v93 offset:11264
  ds_read_b128 v[160:163], v93 offset:16384
  ds_read_b128 v[164:167], v93 offset:17408
  ds_read_b128 v[168:171], v93 offset:18432
  ds_read_b128 v[172:175], v93 offset:19456
  ds_read_b128 v[176:179], v93 offset:24576
  ds_read_b128 v[180:183], v93 offset:25600
  ds_read_b128 v[184:187], v93 offset:26624
  ds_read_b128 v[188:191], v93 offset:27648
  v_cmp_eq_u32 vcc, 0, v94
  v_mov_b32 v26, s48
  v_mov_b32 v27, s49
  v_mov_b32 v28, s50
  v_mov_b32 v29, s51
  s_nop 1
  v_cndmask_b32 v26, 0, v26, vcc
  v_cndmask_b32 v27, 0, v27, vcc
  v_cndmask_b32 v28, 0, v28, vcc
  v_cndmask_b32 v29, 0, v29, vcc
  s_waitcnt lgkmcnt(12)
  v_mfma_f32_16x16x32_bf16 v[192:195], v[48:51], v[128:131], 0
  v_mfma_f32_16x16x32_bf16 v[196:199], v[48:51], v[136:139], 0
  v_mfma_f32_16x16x32_bf16 v[224:227], v[240:243], v[128:131], 0
  v_mfma_f32_16x16x32_bf16 v[192:195], v[52:55], v[132:135], v[192:195]
  v_mfma_f32_16x16x32_bf16 v[196:199], v[52:55], v[140:143], v[196:199]
  v_mfma_f32_16x16x32_bf16 v[224:227], v[240:243], v[132:135], v[224:227]
  v_mfma_f32_16x16x32_bf16 v[192:195], v[56:59], v[136:139], v[192:195]
  v_mfma_f32_16x16x32_bf16 v[196:199], v[64:67], v[128:131], v[196:199]
  v_mfma_f32_16x16x32_bf16 v[192:195], v[60:63], v[140:143], v[192:195]
  v_mfma_f32_16x16x32_bf16 v[196:199], v[68:71], v[132:135], v[196:199]
  s_waitcnt lgkmcnt(8)
  v_mfma_f32_16x16x32_bf16 v[200:203], v[48:51], v[144:147], 0
  v_mfma_f32_16x16x32_bf16 v[204:207], v[48:51], v[152:155], 0
  v_mfma_f32_16x16x32_bf16 v[228:231], v[240:243], v[144:147], 0
  v_mfma_f32_16x16x32_bf16 v[200:203], v[52:55], v[148:151], v[200:203]
  v_mfma_f32_16x16x32_bf16 v[204:207], v[52:55], v[156:159], v[204:207]
  v_mfma_f32_16x16x32_bf16 v[228:231], v[240:243], v[148:151], v[228:231]
  v_mfma_f32_16x16x32_bf16 v[200:203], v[56:59], v[152:155], v[200:203]
  v_mfma_f32_16x16x32_bf16 v[204:207], v[64:67], v[144:147], v[204:207]
  v_mfma_f32_16x16x32_bf16 v[200:203], v[60:63], v[156:159], v[200:203]
  v_mfma_f32_16x16x32_bf16 v[204:207], v[68:71], v[148:151], v[204:207]
  s_waitcnt lgkmcnt(4)
  v_mfma_f32_16x16x32_bf16 v[208:211], v[48:51], v[160:163], 0
  v_mfma_f32_16x16x32_bf16 v[212:215], v[48:51], v[168:171], 0
  v_mfma_f32_16x16x32_bf16 v[232:235], v[240:243], v[160:163], 0
  v_mfma_f32_16x16x32_bf16 v[208:211], v[52:55], v[164:167], v[208:211]
  v_mfma_f32_16x16x32_bf16 v[212:215], v[52:55], v[172:175], v[212:215]
  v_mfma_f32_16x16x32_bf16 v[232:235], v[240:243], v[164:167], v[232:235]
  v_mfma_f32_16x16x32_bf16 v[208:211], v[56:59], v[168:171], v[208:211]
  v_mfma_f32_16x16x32_bf16 v[212:215], v[64:67], v[160:163], v[212:215]
  v_mfma_f32_16x16x32_bf16 v[208:211], v[60:63], v[172:175], v[208:211]
  v_mfma_f32_16x16x32_bf16 v[212:215], v[68:71], v[164:167], v[212:215]
  s_waitcnt lgkmcnt(0)
  v_mfma_f32_16x16x32_bf16 v[216:219], v[48:51], v[176:179], 0
  v_mfma_f32_16x16x32_bf16 v[220:223], v[48:51], v[184:187], 0
  v_mfma_f32_16x16x32_bf16 v[236:239], v[240:243], v[176:179], 0
  v_mfma_f32_16x16x32_bf16 v[216:219], v[52:55], v[180:183], v[216:219]
  v_mfma_f32_16x16x32_bf16 v[220:223], v[52:55], v[188:191], v[220:223]
  v_mfma_f32_16x16x32_bf16 v[236:239], v[240:243], v[180:183], v[236:239]
  v_mfma_f32_16x16x32_bf16 v[216:219], v[56:59], v[184:187], v[216:219]
  v_mfma_f32_16x16x32_bf16 v[220:223], v[64:67], v[176:179], v[220:223]
  v_mfma_f32_16x16x32_bf16 v[216:219], v[60:63], v[188:191], v[216:219]
  v_mfma_f32_16x16x32_bf16 v[220:223], v[68:71], v[180:183], v[220:223]
  s_nop 7
  v_cmp_eq_u32 vcc, 0, v94
  s_nop 1
  v_cndmask_b32 v196, v196, v224, vcc
  v_cndmask_b32 v204, v204, v228, vcc
  v_cndmask_b32 v212, v212, v232, vcc
  v_cndmask_b32 v220, v220, v236, vcc
  v_fma_f32 v192, v192, s44, v26
  v_mul_f32 v193, s44, v193
  v_mul_f32 v194, s44, v194
  v_mul_f32 v195, s44, v195
  v_mul_f32 v196, s44, v196
  v_mul_f32 v197, s44, v197
  v_mul_f32 v198, s44, v198
  v_mul_f32 v199, s44, v199
  v_fma_f32 v200, v200, s45, v27
  v_mul_f32 v201, s45, v201
  v_mul_f32 v202, s45, v202
  v_mul_f32 v203, s45, v203
  v_mul_f32 v204, s45, v204
  v_mul_f32 v205, s45, v205
  v_mul_f32 v206, s45, v206
  v_mul_f32 v207, s45, v207
  v_fma_f32 v208, v208, s46, v28
  v_mul_f32 v209, s46, v209
  v_mul_f32 v210, s46, v210
  v_mul_f32 v211, s46, v211
  v_mul_f32 v212, s46, v212
  v_mul_f32 v213, s46, v213
  v_mul_f32 v214, s46, v214
  v_mul_f32 v215, s46, v215
  v_fma_f32 v216, v216, s47, v29
  v_mul_f32 v217, s47, v217
  v_mul_f32 v218, s47, v218
  v_mul_f32 v219, s47, v219
  v_mul_f32 v220, s47, v220
  v_mul_f32 v221, s47, v221
  v_mul_f32 v222, s47, v222
  v_mul_f32 v223, s47, v223
  v_cvt_pk_bf16_f32 v100, v192, v200
  v_cvt_pk_bf16_f32 v101, v208, v216
  v_cvt_pk_bf16_f32 v102, v196, v204
  v_cvt_pk_bf16_f32 v103, v212, v220
  buffer_store_dwordx4 v[100:103], v94, s[16:19], 0 offen offset:0 sc1
  v_cvt_pk_bf16_f32 v104, v193, v201
  v_cvt_pk_bf16_f32 v105, v209, v217
  v_cvt_pk_bf16_f32 v106, v197, v205
  v_cvt_pk_bf16_f32 v107, v213, v221
  buffer_store_dwordx4 v[104:107], v94, s[16:19], 0 offen offset:512 sc1
  v_cvt_pk_bf16_f32 v108, v194, v202
  v_cvt_pk_bf16_f32 v109, v210, v218
  v_cvt_pk_bf16_f32 v110, v198, v206
  v_cvt_pk_bf16_f32 v111, v214, v222
  buffer_store_dwordx4 v[108:111], v94, s[16:19], 0 offen offset:1024 sc1
  v_cvt_pk_bf16_f32 v112, v195, v203
  v_cvt_pk_bf16_f32 v113, v211, v219
  v_cvt_pk_bf16_f32 v114, v199, v207
  v_cvt_pk_bf16_f32 v115, v215, v223
  buffer_store_dwordx4 v[112:115], v94, s[16:19], 0 offen offset:1536 sc1
  s_nop 1
  v_add_f32_dpp v20, v20, v20 quad_perm:[1,0,3,2] row_mask:0xf bank_mask:0xf
  v_add_f32_dpp v21, v21, v21 quad_perm:[1,0,3,2] row_mask:0xf bank_mask:0xf
  s_nop 1
  v_add_f32_dpp v20, v20, v20 quad_perm:[2,3,0,1] row_mask:0xf bank_mask:0xf
  v_add_f32_dpp v21, v21, v21 quad_perm:[2,3,0,1] row_mask:0xf bank_mask:0xf
  s_nop 1
  v_add_f32_dpp v20, v20, v20 row_half_mirror row_mask:0xf bank_mask:0xf
  v_add_f32_dpp v21, v21, v21 row_half_mirror row_mask:0xf bank_mask:0xf
  s_nop 1
  v_add_f32_dpp v20, v20, v20 row_mirror row_mask:0xf bank_mask:0xf
  v_add_f32_dpp v21, v21, v21 row_mirror row_mask:0xf bank_mask:0xf
  s_add_u32 s20, s32, 0x68000
  s_addc_u32 s21, s33, 0
  s_mov_b32 s22, 0x6000
  s_mov_b32 s23, 0x20000
  s_add_u32 s52, s32, 0x74800
  s_addc_u32 s53, s33, 0
  s_mov_b32 s54, 0x3000
  s_mov_b32 s55, 0x20000
  v_cvt_pk_bf16_f32 v20, v20, v20
  v_lshlrev_b32 v20, 16, v20
  v_add_f32 v22, 1.0, v20
  v_cvt_pk_bf16_f32 v22, v22, v22
  v_lshlrev_b32 v22, 16, v22
  v_lshrrev_b32 v23, 10, v16
  v_cmp_eq_u32 vcc, 1, v23
  v_cmp_eq_u32 s[40:41], 4, v23
  s_or_b64 vcc, vcc, s[40:41]
  s_nop 1
  v_cndmask_b32 v20, v20, v22, vcc
  v_cmp_eq_u32 vcc, 0, v4
  s_and_saveexec_b64 s[42:43], vcc
  v_lshlrev_b32 v24, 2, v16
  buffer_store_dword v20, v24, s[20:23], 0 offen
  v_and_b32 v25, 1023, v16
  v_lshrrev_b32 v26, 5, v25
  v_bfe_u32 v27, v25, 3, 1
  v_lshl_add_u32 v26, v27, 5, v26
  v_lshlrev_b32 v26, 4, v26
  v_and_b32 v27, 3, v25
  v_lshl_add_u32 v26, v27, 2, v26
  v_bfe_u32 v27, v25, 4, 1
  v_bfe_u32 v28, v25, 2, 1
  v_lshl_add_u32 v27, v27, 1, v28
  v_lshl_add_u32 v26, v27, 10, v26
  v_mov_b32 v27, 0x10000
  v_cmp_eq_u32 vcc, 2, v23
  s_nop 1
  v_cndmask_b32 v27, v27, 0, vcc
  v_mov_b32 v28, 4096
  v_cmp_eq_u32 vcc, 4, v23
  s_nop 1
  v_cndmask_b32 v27, v27, v28, vcc
  v_mov_b32 v28, 8192
  v_cmp_eq_u32 vcc, 3, v23
  s_nop 1
  v_cndmask_b32 v27, v27, v28, vcc
  v_add_u32 v26, v26, v27
  buffer_store_dword v20, v26, s[52:55], 0 offen
  s_mov_b64 exec, s[42:43]
  v_add_u32 v16, 4, v16
  v_cvt_pk_bf16_f32 v21, v21, v21
  v_lshlrev_b32 v21, 16, v21
  v_add_f32 v22, 1.0, v21
  v_cvt_pk_bf16_f32 v22, v22, v22
  v_lshlrev_b32 v22, 16, v22
  v_lshrrev_b32 v23, 10, v16
  v_cmp_eq_u32 vcc, 1, v23
  v_cmp_eq_u32 s[40:41], 4, v23
  s_or_b64 vcc, vcc, s[40:41]
  s_nop 1
  v_cndmask_b32 v21, v21, v22, vcc
  v_cmp_eq_u32 vcc, 0, v4
  v_cmp_gt_u32 s[40:41], 2, v3
  s_and_b64 vcc, vcc, s[40:41]
  s_and_saveexec_b64 s[42:43], vcc
  v_lshlrev_b32 v24, 2, v16
  buffer_store_dword v21, v24, s[20:23], 0 offen
  v_and_b32 v25, 1023, v16
  v_lshrrev_b32 v26, 5, v25
  v_bfe_u32 v27, v25, 3, 1
  v_lshl_add_u32 v26, v27, 5, v26
  v_lshlrev_b32 v26, 4, v26
  v_and_b32 v27, 3, v25
  v_lshl_add_u32 v26, v27, 2, v26
  v_bfe_u32 v27, v25, 4, 1
  v_bfe_u32 v28, v25, 2, 1
  v_lshl_add_u32 v27, v27, 1, v28
  v_lshl_add_u32 v26, v27, 10, v26
  v_mov_b32 v27, 0x10000
  v_cmp_eq_u32 vcc, 2, v23
  s_nop 1
  v_cndmask_b32 v27, v27, 0, vcc
  v_mov_b32 v28, 4096
  v_cmp_eq_u32 vcc, 4, v23
  s_nop 1
  v_cndmask_b32 v27, v27, v28, vcc
  v_mov_b32 v28, 8192
  v_cmp_eq_u32 vcc, 3, v23
  s_nop 1
  v_cndmask_b32 v27, v27, v28, vcc
  v_add_u32 v26, v26, v27
  buffer_store_dword v21, v26, s[52:55], 0 offen
  s_mov_b64 exec, s[42:43]
kb_kernel_fin:
  s_endpgm
kb_kernel_ctab:
  s_load_dwordx2 s[32:33], s[0:1], 104
  v_cmp_gt_u32 vcc, 64, v0
  s_and_saveexec_b64 s[40:41], vcc
  s_cbranch_execz kb_kernel_end
  v_lshrrev_b32 v2, 5, v0
  v_and_b32 v3, 31, v0
  v_lshrrev_b32 v6, 4, v3
  v_lshlrev_b32 v6, 4, v6
  v_bfe_u32 v7, v3, 2, 1
  v_lshl_add_u32 v6, v7, 3, v6
  v_bfe_u32 v7, v3, 3, 1
  v_lshl_add_u32 v6, v7, 2, v6
  v_and_b32 v7, 3, v3
  v_add_u32 v6, v6, v7
  v_lshlrev_b32 v10, 3, v2
  v_mul_u32_u24 v10, v10, v6
  v_and_b32 v11, 31, v10
  v_cvt_f32_u32 v112, v11
  v_mul_f32 v112, 0x3d000000, v112
  v_cos_f32 v104, v112
  v_sin_f32 v112, v112
  v_add_u32 v10, v10, v6
  v_and_b32 v11, 31, v10
  v_cvt_f32_u32 v113, v11
  v_mul_f32 v113, 0x3d000000, v113
  v_cos_f32 v105, v113
  v_sin_f32 v113, v113
  v_add_u32 v10, v10, v6
  v_and_b32 v11, 31, v10
  v_cvt_f32_u32 v114, v11
  v_mul_f32 v114, 0x3d000000, v114
  v_cos_f32 v106, v114
  v_sin_f32 v114, v114
  v_add_u32 v10, v10, v6
  v_and_b32 v11, 31, v10
  v_cvt_f32_u32 v115, v11
  v_mul_f32 v115, 0x3d000000, v115
  v_cos_f32 v107, v115
  v_sin_f32 v115, v115
  v_add_u32 v10, v10, v6
  v_and_b32 v11, 31, v10
  v_cvt_f32_u32 v116, v11
  v_mul_f32 v116, 0x3d000000, v116
  v_cos_f32 v108, v116
  v_sin_f32 v116, v116
  v_add_u32 v10, v10, v6
  v_and_b32 v11, 31, v10
  v_cvt_f32_u32 v117, v11
  v_mul_f32 v117, 0x3d000000, v117
  v_cos_f32 v109, v117
  v_sin_f32 v117, v117
  v_add_u32 v10, v10, v6
  v_and_b32 v11, 31, v10
  v_cvt_f32_u32 v118, v11
  v_mul_f32 v118, 0x3d000000, v118
  v_cos_f32 v110, v118
  v_sin_f32 v118, v118
  v_add_u32 v10, v10, v6
  v_and_b32 v11, 31, v10
  v_cvt_f32_u32 v119, v11
  v_mul_f32 v119, 0x3d000000, v119
  v_cos_f32 v111, v119
  v_sin_f32 v119, v119
  v_and_b32 v11, 1, v6
  v_sub_u32 v12, 0, v11
  v_and_b32 v12, 0x80008000, v12
  v_cvt_pk_bf16_f32 v32, v104, v105
  v_cvt_pk_bf16_f32 v40, v112, v113
  v_cvt_pk_bf16_f32 v33, v106, v107
  v_cvt_pk_bf16_f32 v41, v114, v115
  v_cvt_pk_bf16_f32 v34, v108, v109
  v_cvt_pk_bf16_f32 v42, v116, v117
  v_cvt_pk_bf16_f32 v35, v110, v111
  v_cvt_pk_bf16_f32 v43, v118, v119
  v_xor_b32 v36, v12, v32
  v_xor_b32 v44, v12, v40
  v_xor_b32 v37, v12, v33
  v_xor_b32 v45, v12, v41
  v_xor_b32 v38, v12, v34
  v_xor_b32 v46, v12, v42
  v_xor_b32 v39, v12, v35
  v_xor_b32 v47, v12, v43
  v_xor_b32 v48, 0x80008000, v40
  v_xor_b32 v49, 0x80008000, v41
  v_xor_b32 v50, 0x80008000, v42
  v_xor_b32 v51, 0x80008000, v43
  v_xor_b32 v52, 0x80008000, v44
  v_xor_b32 v53, 0x80008000, v45
  v_xor_b32 v54, 0x80008000, v46
  v_xor_b32 v55, 0x80008000, v47
  v_lshlrev_b32 v10, 2, v2
  v_add_u32 v11, 0, v10
  v_mul_u32_u24 v11, v11, v3
  v_and_b32 v11, 31, v11
  v_cvt_f32_u32 v112, v11
  v_mul_f32 v112, 0x3d000000, v112
  v_cos_f32 v104, v112
  v_sin_f32 v112, v112
  v_add_u32 v11, 1, v10
  v_mul_u32_u24 v11, v11, v3
  v_and_b32 v11, 31, v11
  v_cvt_f32_u32 v113, v11
  v_mul_f32 v113, 0x3d000000, v113
  v_cos_f32 v105, v113
  v_sin_f32 v113, v113
  v_add_u32 v11, 2, v10
  v_mul_u32_u24 v11, v11, v3
  v_and_b32 v11, 31, v11
  v_cvt_f32_u32 v114, v11
  v_mul_f32 v114, 0x3d000000, v114
  v_cos_f32 v106, v114
  v_sin_f32 v114, v114
  v_add_u32 v11, 3, v10
  v_mul_u32_u24 v11, v11, v3
  v_and_b32 v11, 31, v11
  v_cvt_f32_u32 v115, v11
  v_mul_f32 v115, 0x3d000000, v115
  v_cos_f32 v107, v115
  v_sin_f32 v115, v115
  v_add_u32 v11, 8, v10
  v_mul_u32_u24 v11, v11, v3
  v_and_b32 v11, 31, v11
  v_cvt_f32_u32 v116, v11
  v_mul_f32 v116, 0x3d000000, v116
  v_cos_f32 v108, v116
  v_sin_f32 v116, v116
  v_add_u32 v11, 9, v10
  v_mul_u32_u24 v11, v11, v3
  v_and_b32 v11, 31, v11
  v_cvt_f32_u32 v117, v11
  v_mul_f32 v117, 0x3d000000, v117
  v_cos_f32 v109, v117
  v_sin_f32 v117, v117
  v_add_u32 v11, 10, v10
  v_mul_u32_u24 v11, v11, v3
  v_and_b32 v11, 31, v11
  v_cvt_f32_u32 v118, v11
  v_mul_f32 v118, 0x3d000000, v118
  v_cos_f32 v110, v118
  v_sin_f32 v118, v118
  v_add_u32 v11, 11, v10
  v_mul_u32_u24 v11, v11, v3
  v_and_b32 v11, 31, v11
  v_cvt_f32_u32 v119, v11
  v_mul_f32 v119, 0x3d000000, v119
  v_cos_f32 v111, v119
  v_sin_f32 v119, v119
  v_and_b32 v11, 1, v3
  v_sub_u32 v12, 0, v11
  v_and_b32 v12, 0x80008000, v12
  v_cvt_pk_bf16_f32 v56, v104, v105
  v_cvt_pk_bf16_f32 v64, v112, v113
  v_cvt_pk_bf16_f32 v57, v106, v107
  v_cvt_pk_bf16_f32 v65, v114, v115
  v_cvt_pk_bf16_f32 v58, v108, v109
  v_cvt_pk_bf16_f32 v66, v116, v117
  v_cvt_pk_bf16_f32 v59, v110, v111
  v_cvt_pk_bf16_f32 v67, v118, v119
  v_xor_b32 v60, v12, v56
  v_xor_b32 v68, v12, v64
  v_xor_b32 v61, v12, v57
  v_xor_b32 v69, v12, v65
  v_xor_b32 v62, v12, v58
  v_xor_b32 v70, v12, v66
  v_xor_b32 v63, v12, v59
  v_xor_b32 v71, v12, v67
  v_add_u32 v11, 0, v10
  v_mul_u32_u24 v11, v11, v6
  v_cvt_f32_u32 v88, v11
  v_mul_f32 v88, 0x3a800000, v88
  v_cos_f32 v72, v88
  v_sin_f32 v88, v88
  v_add_u32 v11, 1, v10
  v_mul_u32_u24 v11, v11, v6
  v_cvt_f32_u32 v89, v11
  v_mul_f32 v89, 0x3a800000, v89
  v_cos_f32 v73, v89
  v_sin_f32 v89, v89
  v_add_u32 v11, 2, v10
  v_mul_u32_u24 v11, v11, v6
  v_cvt_f32_u32 v90, v11
  v_mul_f32 v90, 0x3a800000, v90
  v_cos_f32 v74, v90
  v_sin_f32 v90, v90
  v_add_u32 v11, 3, v10
  v_mul_u32_u24 v11, v11, v6
  v_cvt_f32_u32 v91, v11
  v_mul_f32 v91, 0x3a800000, v91
  v_cos_f32 v75, v91
  v_sin_f32 v91, v91
  v_add_u32 v11, 8, v10
  v_mul_u32_u24 v11, v11, v6
  v_cvt_f32_u32 v92, v11
  v_mul_f32 v92, 0x3a800000, v92
  v_cos_f32 v76, v92
  v_sin_f32 v92, v92
  v_add_u32 v11, 9, v10
  v_mul_u32_u24 v11, v11, v6
  v_cvt_f32_u32 v93, v11
  v_mul_f32 v93, 0x3a800000, v93
  v_cos_f32 v77, v93
  v_sin_f32 v93, v93
  v_add_u32 v11, 10, v10
  v_mul_u32_u24 v11, v11, v6
  v_cvt_f32_u32 v94, v11
  v_mul_f32 v94, 0x3a800000, v94
  v_cos_f32 v78, v94
  v_sin_f32 v94, v94
  v_add_u32 v11, 11, v10
  v_mul_u32_u24 v11, v11, v6
  v_cvt_f32_u32 v95, v11
  v_mul_f32 v95, 0x3a800000, v95
  v_cos_f32 v79, v95
  v_sin_f32 v95, v95
  v_add_u32 v11, 16, v10
  v_mul_u32_u24 v11, v11, v6
  v_cvt_f32_u32 v96, v11
  v_mul_f32 v96, 0x3a800000, v96
  v_cos_f32 v80, v96
  v_sin_f32 v96, v96
  v_add_u32 v11, 17, v10
  v_mul_u32_u24 v11, v11, v6
  v_cvt_f32_u32 v97, v11
  v_mul_f32 v97, 0x3a800000, v97
  v_cos_f32 v81, v97
  v_sin_f32 v97, v97
  v_add_u32 v11, 18, v10
  v_mul_u32_u24 v11, v11, v6
  v_cvt_f32_u32 v98, v11
  v_mul_f32 v98, 0x3a800000, v98
  v_cos_f32 v82, v98
  v_sin_f32 v98, v98
  v_add_u32 v11, 19, v10
  v_mul_u32_u24 v11, v11, v6
  v_cvt_f32_u32 v99, v11
  v_mul_f32 v99, 0x3a800000, v99
  v_cos_f32 v83, v99
  v_sin_f32 v99, v99
  v_add_u32 v11, 24, v10
  v_mul_u32_u24 v11, v11, v6
  v_cvt_f32_u32 v100, v11
  v_mul_f32 v100, 0x3a800000, v100
  v_cos_f32 v84, v100
  v_sin_f32 v100, v100
  v_add_u32 v11, 25, v10
  v_mul_u32_u24 v11, v11, v6
  v_cvt_f32_u32 v101, v11
  v_mul_f32 v101, 0x3a800000, v101
  v_cos_f32 v85, v101
  v_sin_f32 v101, v101
  v_add_u32 v11, 26, v10
  v_mul_u32_u24 v11, v11, v6
  v_cvt_f32_u32 v102, v11
  v_mul_f32 v102, 0x3a800000, v102
  v_cos_f32 v86, v102
  v_sin_f32 v102, v102
  v_add_u32 v11, 27, v10
  v_mul_u32_u24 v11, v11, v6
  v_cvt_f32_u32 v103, v11
  v_mul_f32 v103, 0x3a800000, v103
  v_cos_f32 v87, v103
  v_sin_f32 v103, v103
  s_waitcnt lgkmcnt(0)
  s_add_u32 s12, s32, 0x70000
  s_addc_u32 s13, s33, 0
  s_mov_b32 s14, 0x4800
  s_mov_b32 s15, 0x20000
  v_lshlrev_b32 v5, 4, v0
  s_mov_b32 s36, 0
  buffer_store_dwordx4 v[32:35], v5, s[12:15], s36 offen offset:0
  buffer_store_dwordx4 v[36:39], v5, s[12:15], s36 offen offset:1024
  buffer_store_dwordx4 v[40:43], v5, s[12:15], s36 offen offset:2048
  buffer_store_dwordx4 v[44:47], v5, s[12:15], s36 offen offset:3072
  s_add_u32 s36, s36, 4096
  buffer_store_dwordx4 v[48:51], v5, s[12:15], s36 offen offset:0
  buffer_store_dwordx4 v[52:55], v5, s[12:15], s36 offen offset:1024
  buffer_store_dwordx4 v[56:59], v5, s[12:15], s36 offen offset:2048
  buffer_store_dwordx4 v[60:63], v5, s[12:15], s36 offen offset:3072
  s_add_u32 s36, s36, 4096
  buffer_store_dwordx4 v[64:67], v5, s[12:15], s36 offen offset:0
  buffer_store_dwordx4 v[68:71], v5, s[12:15], s36 offen offset:1024
  buffer_store_dwordx4 v[72:75], v5, s[12:15], s36 offen offset:2048
  buffer_store_dwordx4 v[76:79], v5, s[12:15], s36 offen offset:3072
  s_add_u32 s36, s36, 4096
  buffer_store_dwordx4 v[80:83], v5, s[12:15], s36 offen offset:0
  buffer_store_dwordx4 v[84:87], v5, s[12:15], s36 offen offset:1024
  buffer_store_dwordx4 v[88:91], v5, s[12:15], s36 offen offset:2048
  buffer_store_dwordx4 v[92:95], v5, s[12:15], s36 offen offset:3072
  s_add_u32 s36, s36, 4096
  buffer_store_dwordx4 v[96:99], v5, s[12:15], s36 offen offset:0
  buffer_store_dwordx4 v[100:103], v5, s[12:15], s36 offen offset:1024
kb_kernel_end:
  s_endpgm

.globl kc_kernel
.p2align 8
.type kc_kernel,@function
kc_kernel:
  s_cmp_ge_u32 s2, 256
  s_cbranch_scc1 kc_kernel_end
  s_load_dwordx2 s[32:33], s[0:1], 104
  v_mov_b32 v30, v0
  v_lshrrev_b32 v1, 6, v0
  v_and_b32 v0, 63, v0
  v_readfirstlane_b32 s28, v1
  s_load_dwordx2 s[4:5], s[0:1], 0
  s_load_dwordx2 s[6:7], s[0:1], 56
  s_load_dwordx2 s[42:43], s[0:1], 48
  s_and_b32 s34, s2, 7
  s_lshl_b32 s34, s34, 5
  s_lshr_b32 s35, s2, 3
  s_add_u32 s34, s34, s35
  s_lshl_b32 s34, s34, 2
  v_lshrrev_b32 v2, 2, v0
  v_lshrrev_b32 v4, 4, v0
  v_sub_u32 v3, v0, v4
  v_and_b32 v3, 3, v3
  s_mov_b32 s35, 16384
  v_mul_lo_u32 v8, v2, s35
  v_add_u32 v3, s34, v3
  v_lshl_add_u32 v8, v3, 4, v8
  v_lshlrev_b32 v5, 4, v0
  v_add_u32 v29, 16384, v5
  v_lshrrev_b32 v2, 5, v0
  v_and_b32 v3, 31, v0
  v_lshlrev_b32 v4, 6, v3
  v_lshl_add_u32 v4, v2, 4, v4
  s_and_b32 s38, s28, 3
  s_add_u32 s36, s34, s38
  s_sub_u32 s39, 2048, s36
  s_cmp_eq_u32 s36, 0
  s_cselect_b32 s39, 1024, s39
  s_cmp_ge_u32 s28, 4
  s_cselect_b32 s36, s39, s36
  s_lshl_b32 s37, s36, 11
  s_waitcnt lgkmcnt(0)
  s_add_u32 s8, s32, 0x500000
  s_addc_u32 s9, s33, 0
  s_mov_b32 s10, 0x400000
  s_mov_b32 s11, 0x20000
  s_lshl_b32 s38, s28, 1
  s_add_u32 s38, s38, 0
  s_lshl_b32 s39, s38, 10
  s_mov_b32 m0, s39
  s_mul_i32 s38, s38, 262144
  buffer_load_dwordx4 v8, s[8:11], s38 offen lds
  s_lshl_b32 s38, s28, 1
  s_add_u32 s38, s38, 1
  s_lshl_b32 s39, s38, 10
  s_mov_b32 m0, s39
  s_mul_i32 s38, s38, 262144
  buffer_load_dwordx4 v8, s[8:11], s38 offen lds
  s_add_u32 s48, s32, 0x70000
  s_addc_u32 s49, s33, 0
  s_mov_b32 s50, 0x7800
  s_mov_b32 s51, 0x20000
  s_lshl_b32 s38, s28, 12
  s_add_u32 m0, s38, 16384
  s_nop 0
  buffer_load_dwordx4 v5, s[48:51], s38 offen offset:0 lds
  buffer_load_dwordx4 v5, s[48:51], s38 offen offset:1024 lds
  buffer_load_dwordx4 v5, s[48:51], s38 offen offset:2048 lds
  buffer_load_dwordx4 v5, s[48:51], s38 offen offset:3072 lds
  s_add_u32 s16, s4, s37
  s_addc_u32 s17, s5, 0
  s_mov_b32 s18, 0x800
  s_mov_b32 s19, 0x20000
  buffer_load_dwordx4 v[200:203], v4, s[16:19], 0 offen
  buffer_load_dwordx4 v[204:207], v4, s[16:19], 0 offen offset:32
  s_add_u32 s20, s32, s37
  s_addc_u32 s21, s33, 0
  s_add_u32 s20, s20, 0xd00000
  s_addc_u32 s21, s21, 0
  s_mov_b32 s22, 0x800
  s_mov_b32 s23, 0x20000
  s_add_u32 s24, s32, 0x1100000
  s_addc_u32 s25, s33, 0
  s_mov_b32 s26, 0x400000
  s_mov_b32 s27, 0x20000
  v_lshrrev_b32 v10, 4, v0
  v_bfe_u32 v11, v0, 2, 2
  v_and_b32 v12, 3, v0
  v_and_b32 v13, 1, v10
  v_lshl_add_u32 v16, v13, 2, v12
  v_lshrrev_b32 v14, 1, v10
  v_lshl_add_u32 v14, v14, 3, v11
  v_lshlrev_b32 v14, 9, v14
  v_lshl_add_u32 v14, v16, 6, v14
  v_and_b32 v15, 1, v11
  v_lshl_add_u32 v15, v15, 1, v13
  s_and_b32 s38, s28, 3
  v_add_u32 v15, s38, v15
  v_and_b32 v15, 3, v15
  v_lshl_add_u32 v14, v15, 4, v14
  v_mul_u32_u24 v17, 528, v3
  v_lshl_add_u32 v17, v2, 7, v17
  s_lshl_b32 s38, s28, 4
  s_add_u32 s38, s38, 49152
  v_add_u32 v17, s38, v17
  v_lshrrev_b32 v18, 3, v0
  v_and_b32 v19, 7, v0
  v_lshrrev_b32 v20, 2, v18
  v_and_b32 v21, 3, v18
  v_mul_u32_u24 v22, 528, v20
  v_lshl_add_u32 v22, v21, 7, v22
  v_lshl_add_u32 v22, v19, 4, v22
  s_mul_i32 s38, s28, 2112
  s_add_u32 s38, s38, 49152
  v_add_u32 v22, s38, v22
  v_and_b32 v24, 3, v19
  v_add_u32 v24, s34, v24
  v_sub_u32 v25, 2048, v24
  v_mov_b32 v26, 1024
  v_cmp_eq_u32 vcc, 0, v24
  s_nop 1
  v_cndmask_b32 v25, v25, v26, vcc
  v_cmp_lt_u32 vcc, 3, v19
  s_nop 1
  v_cndmask_b32 v24, v24, v25, vcc
  v_lshrrev_b32 v25, 8, v24
  v_lshlrev_b32 v23, 19, v25
  v_bfe_u32 v25, v24, 4, 4
  v_lshl_add_u32 v23, v25, 10, v23
  v_and_b32 v25, 15, v24
  v_lshl_add_u32 v23, v25, 4, v23
  v_lshl_add_u32 v23, v20, 14, v23
  v_lshl_add_u32 v23, v21, 8, v23
  s_lshl_b32 s41, s28, 16
  s_cmp_ge_u32 s28, 4
  s_cselect_b32 s40, 0x80008000, 0
  s_waitcnt vmcnt(0)
  s_barrier
  s_mov_b32 s44, s6
  s_mov_b32 s45, s7
  s_mov_b32 s46, 0x700000
  s_mov_b32 s47, 0x20000
  s_lshl_b32 s38, s2, 9
  v_add_u32 v31, s38, v30
  v_lshlrev_b32 v31, 6, v31
  buffer_load_dword v120, v31, s[44:47], 0 offen
  ds_read_b64_tr_b16 v[104:105], v14 offset:0
  ds_read_b64_tr_b16 v[106:107], v14 offset:2048
  ds_read_b64_tr_b16 v[108:109], v14 offset:8192
  ds_read_b64_tr_b16 v[110:111], v14 offset:10240
  ds_read_b64_tr_b16 v[112:113], v14 offset:8
  ds_read_b64_tr_b16 v[114:115], v14 offset:2056
  ds_read_b64_tr_b16 v[116:117], v14 offset:8200
  ds_read_b64_tr_b16 v[118:119], v14 offset:10248
  ds_read_b128 v[32:35], v29 offset:0
  ds_read_b128 v[36:39], v29 offset:1024
  ds_read_b128 v[40:43], v29 offset:2048
  ds_read_b128 v[44:47], v29 offset:3072
  ds_read_b128 v[48:51], v29 offset:4096
  ds_read_b128 v[52:55], v29 offset:5120
  s_waitcnt lgkmcnt(0)
  v_xor_b32 v112, s40, v112
  v_xor_b32 v113, s40, v113
  v_xor_b32 v114, s40, v114
  v_xor_b32 v115, s40, v115
  v_xor_b32 v116, s40, v116
  v_xor_b32 v117, s40, v117
  v_xor_b32 v118, s40, v118
  v_xor_b32 v119, s40, v119
  s_and_b32 s38, s28, 3
  s_or_b32 s38, s38, s34
  s_cmp_lg_u32 s38, 0
  s_cbranch_scc1 kc_kernel_nosp
  s_cmp_eq_u32 s28, 0
  s_cbranch_scc1 kc_kernel_sp0
  v_xor_b32 v104, s40, v112
  v_xor_b32 v105, s40, v113
  v_xor_b32 v106, s40, v114
  v_xor_b32 v107, s40, v115
  v_xor_b32 v108, s40, v116
  v_xor_b32 v109, s40, v117
  v_xor_b32 v110, s40, v118
  v_xor_b32 v111, s40, v119
kc_kernel_sp0:
  v_mov_b32 v112, 0
  v_mov_b32 v113, 0
  v_mov_b32 v114, 0
  v_mov_b32 v115, 0
  v_mov_b32 v116, 0
  v_mov_b32 v117, 0
  v_mov_b32 v118, 0
  v_mov_b32 v119, 0
kc_kernel_nosp:
  s_nop 1
  v_mfma_f32_32x32x16_bf16 v[128:143], v[104:107], v[32:35], 0
  v_mfma_f32_32x32x16_bf16 v[144:159], v[104:107], v[48:51], 0
  v_mfma_f32_32x32x16_bf16 v[128:143], v[108:111], v[36:39], v[128:143]
  v_mfma_f32_32x32x16_bf16 v[144:159], v[108:111], v[52:55], v[144:159]
  v_mfma_f32_32x32x16_bf16 v[128:143], v[112:115], v[40:43], v[128:143]
  v_mfma_f32_32x32x16_bf16 v[144:159], v[112:115], v[32:35], v[144:159]
  v_mfma_f32_32x32x16_bf16 v[128:143], v[116:119], v[44:47], v[128:143]
  v_mfma_f32_32x32x16_bf16 v[144:159], v[116:119], v[36:39], v[144:159]
  ds_read_b128 v[72:75], v29 offset:10240
  ds_read_b128 v[76:79], v29 offset:11264
  ds_read_b128 v[80:83], v29 offset:12288
  ds_read_b128 v[84:87], v29 offset:13312
  ds_read_b128 v[88:91], v29 offset:14336
  ds_read_b128 v[92:95], v29 offset:15360
  ds_read_b128 v[96:99], v29 offset:16384
  ds_read_b128 v[100:103], v29 offset:17408
  ds_read_b128 v[56:59], v29 offset:6144
  ds_read_b128 v[60:63], v29 offset:7168
  ds_read_b128 v[64:67], v29 offset:8192
  ds_read_b128 v[68:71], v29 offset:9216
  v_lshlrev_b32 v176, 16, v200
  v_and_b32 v177, 0xffff0000, v200
  v_lshlrev_b32 v178, 16, v201
  v_and_b32 v179, 0xffff0000, v201
  v_lshlrev_b32 v180, 16, v202
  v_and_b32 v181, 0xffff0000, v202
  v_lshlrev_b32 v182, 16, v203
  v_and_b32 v183, 0xffff0000, v203
  v_lshlrev_b32 v184, 16, v204
  v_and_b32 v185, 0xffff0000, v204
  v_lshlrev_b32 v186, 16, v205
  v_and_b32 v187, 0xffff0000, v205
  v_lshlrev_b32 v188, 16, v206
  v_and_b32 v189, 0xffff0000, v206
  v_lshlrev_b32 v190, 16, v207
  v_and_b32 v191, 0xffff0000, v207
  s_waitcnt lgkmcnt(4)
  ds_read_b128 v[208:211], v29 offset:18432
  ds_read_b128 v[212:215], v29 offset:19456
  ds_read_b128 v[216:219], v29 offset:20480
  ds_read_b128 v[220:223], v29 offset:21504
  ds_read_b128 v[224:227], v29 offset:22528
  ds_read_b128 v[228:231], v29 offset:23552
  ds_read_b128 v[232:235], v29 offset:24576
  ds_read_b128 v[236:239], v29 offset:25600
  ds_read_b128 v[240:243], v29 offset:26624
  ds_read_b128 v[244:247], v29 offset:27648
  ds_read_b128 v[248:251], v29 offset:28672
  ds_read_b128 v[252:255], v29 offset:29696
  v_pk_mul_f32 v[160:161], v[128:129], v[72:73]
  v_pk_mul_f32 v[162:163], v[130:131], v[74:75]
  v_pk_mul_f32 v[164:165], v[132:133], v[76:77]
  v_pk_mul_f32 v[166:167], v[134:135], v[78:79]
  v_pk_mul_f32 v[168:169], v[136:137], v[80:81]
  v_pk_mul_f32 v[170:171], v[138:139], v[82:83]
  v_pk_mul_f32 v[172:173], v[140:141], v[84:85]
  v_pk_mul_f32 v[174:175], v[142:143], v[86:87]
  v_pk_fma_f32 v[160:161], v[144:145], v[88:89], v[160:161]
  v_pk_fma_f32 v[162:163], v[146:147], v[90:91], v[162:163]
  v_pk_fma_f32 v[164:165], v[148:149], v[92:93], v[164:165]
  v_pk_fma_f32 v[166:167], v[150:151], v[94:95], v[166:167]
  v_pk_fma_f32 v[168:169], v[152:153], v[96:97], v[168:169]
  v_pk_fma_f32 v[170:171], v[154:155], v[98:99], v[170:171]
  v_pk_fma_f32 v[172:173], v[156:157], v[100:101], v[172:173]
  v_pk_fma_f32 v[174:175], v[158:159], v[102:103], v[174:175]
  v_pk_mul_f32 v[144:145], v[144:145], v[72:73]
  v_pk_mul_f32 v[146:147], v[146:147], v[74:75]
  v_pk_mul_f32 v[148:149], v[148:149], v[76:77]
  v_pk_mul_f32 v[150:151], v[150:151], v[78:79]
  v_pk_mul_f32 v[152:153], v[152:153], v[80:81]
  v_pk_mul_f32 v[154:155], v[154:155], v[82:83]
  v_pk_mul_f32 v[156:157], v[156:157], v[84:85]
  v_pk_mul_f32 v[158:159], v[158:159], v[86:87]
  v_pk_fma_f32 v[144:145], v[128:129], v[88:89], v[144:145] neg_lo:[1,0,0] neg_hi:[1,0,0]
  v_pk_fma_f32 v[146:147], v[130:131], v[90:91], v[146:147] neg_lo:[1,0,0] neg_hi:[1,0,0]
  v_pk_fma_f32 v[148:149], v[132:133], v[92:93], v[148:149] neg_lo:[1,0,0] neg_hi:[1,0,0]
  v_pk_fma_f32 v[150:151], v[134:135], v[94:95], v[150:151] neg_lo:[1,0,0] neg_hi:[1,0,0]
  v_pk_fma_f32 v[152:153], v[136:137], v[96:97], v[152:153] neg_lo:[1,0,0] neg_hi:[1,0,0]
  v_pk_fma_f32 v[154:155], v[138:139], v[98:99], v[154:155] neg_lo:[1,0,0] neg_hi:[1,0,0]
  v_pk_fma_f32 v[156:157], v[140:141], v[100:101], v[156:157] neg_lo:[1,0,0] neg_hi:[1,0,0]
  v_pk_fma_f32 v[158:159], v[142:143], v[102:103], v[158:159] neg_lo:[1,0,0] neg_hi:[1,0,0]
  v_cvt_pk_bf16_f32 v104, v160, v161
  v_cvt_pk_bf16_f32 v112, v144, v145
  v_cvt_pk_bf16_f32 v105, v162, v163
  v_cvt_pk_bf16_f32 v113, v146, v147
  v_cvt_pk_bf16_f32 v106, v164, v165
  v_cvt_pk_bf16_f32 v114, v148, v149
  v_cvt_pk_bf16_f32 v107, v166, v167
  v_cvt_pk_bf16_f32 v115, v150, v151
  v_cvt_pk_bf16_f32 v108, v168, v169
  v_cvt_pk_bf16_f32 v116, v152, v153
  v_cvt_pk_bf16_f32 v109, v170, v171
  v_cvt_pk_bf16_f32 v117, v154, v155
  v_cvt_pk_bf16_f32 v110, v172, v173
  v_cvt_pk_bf16_f32 v118, v156, v157
  v_cvt_pk_bf16_f32 v111, v174, v175
  v_cvt_pk_bf16_f32 v119, v158, v159
  s_waitcnt lgkmcnt(12)
  v_mfma_f32_32x32x16_bf16 v[128:143], v[104:107], v[56:59], 0
  v_mfma_f32_32x32x16_bf16 v[128:143], v[108:111], v[60:63], v[128:143]
  v_mfma_f32_32x32x16_bf16 v[128:143], v[112:115], v[64:67], v[128:143]
  v_mfma_f32_32x32x16_bf16 v[128:143], v[116:119], v[68:71], v[128:143]
  s_nop 15
  s_waitcnt lgkmcnt(0)
  v_pk_fma_f32 v[176:177], v[128:129], v[208:209], v[176:177]
  v_pk_fma_f32 v[178:179], v[130:131], v[210:211], v[178:179]
  v_pk_fma_f32 v[180:181], v[132:133], v[212:213], v[180:181]
  v_pk_fma_f32 v[182:183], v[134:135], v[214:215], v[182:183]
  v_pk_fma_f32 v[184:185], v[136:137], v[216:217], v[184:185]
  v_pk_fma_f32 v[186:187], v[138:139], v[218:219], v[186:187]
  v_pk_fma_f32 v[188:189], v[140:141], v[220:221], v[188:189]
  v_pk_fma_f32 v[190:191], v[142:143], v[222:223], v[190:191]
  v_cvt_pk_bf16_f32 v200, v176, v177
  v_cvt_pk_bf16_f32 v201, v178, v179
  v_cvt_pk_bf16_f32 v202, v180, v181
  v_cvt_pk_bf16_f32 v203, v182, v183
  v_cvt_pk_bf16_f32 v204, v184, v185
  v_cvt_pk_bf16_f32 v205, v186, v187
  v_cvt_pk_bf16_f32 v206, v188, v189
  v_cvt_pk_bf16_f32 v207, v190, v191
  s_lshl_b32 s38, s28, 11
  s_add_u32 s38, s38, 66048
  v_add_u32 v27, s38, v4
  v_add_u32 v28, s38, v5
  ds_write_b128 v27, v[200:203]
  ds_write_b128 v27, v[204:207] offset:32
  s_waitcnt lgkmcnt(0)
  ds_read_b128 v[96:99], v28
  ds_read_b128 v[100:103], v28 offset:1024
  s_waitcnt lgkmcnt(1)
  buffer_store_dwordx4 v[96:99], v5, s[20:23], 0 offen sc1
  s_waitcnt lgkmcnt(0)
  buffer_store_dwordx4 v[100:103], v5, s[20:23], 0 offen offset:1024 sc1
  v_lshlrev_b32 v176, 16, v200
  v_and_b32 v177, 0xffff0000, v200
  v_lshlrev_b32 v178, 16, v201
  v_and_b32 v179, 0xffff0000, v201
  v_lshlrev_b32 v180, 16, v202
  v_and_b32 v181, 0xffff0000, v202
  v_lshlrev_b32 v182, 16, v203
  v_and_b32 v183, 0xffff0000, v203
  v_lshlrev_b32 v184, 16, v204
  v_and_b32 v185, 0xffff0000, v204
  v_lshlrev_b32 v186, 16, v205
  v_and_b32 v187, 0xffff0000, v205
  v_lshlrev_b32 v188, 16, v206
  v_and_b32 v189, 0xffff0000, v206
  v_lshlrev_b32 v190, 16, v207
  v_and_b32 v191, 0xffff0000, v207
  v_pk_add_f32 v[10:11], v[176:177], v[178:179]
  v_pk_mul_f32 v[12:13], v[176:177], v[176:177]
  v_pk_fma_f32 v[12:13], v[178:179], v[178:179], v[12:13]
  v_pk_add_f32 v[10:11], v[10:11], v[180:181]
  v_pk_fma_f32 v[12:13], v[180:181], v[180:181], v[12:13]
  v_pk_add_f32 v[10:11], v[10:11], v[182:183]
  v_pk_fma_f32 v[12:13], v[182:183], v[182:183], v[12:13]
  v_pk_add_f32 v[10:11], v[10:11], v[184:185]
  v_pk_fma_f32 v[12:13], v[184:185], v[184:185], v[12:13]
  v_pk_add_f32 v[10:11], v[10:11], v[186:187]
  v_pk_fma_f32 v[12:13], v[186:187], v[186:187], v[12:13]
  v_pk_add_f32 v[10:11], v[10:11], v[188:189]
  v_pk_fma_f32 v[12:13], v[188:189], v[188:189], v[12:13]
  v_pk_add_f32 v[10:11], v[10:11], v[190:191]
  v_pk_fma_f32 v[12:13], v[190:191], v[190:191], v[12:13]
  v_add_f32 v10, v10, v11
  v_add_f32 v12, v12, v13
  s_nop 1
  v_add_f32_dpp v10, v10, v10 quad_perm:[1,0,3,2] row_mask:0xf bank_mask:0xf
  v_add_f32_dpp v12, v12, v12 quad_perm:[1,0,3,2] row_mask:0xf bank_mask:0xf
  s_nop 1
  v_add_f32_dpp v10, v10, v10 quad_perm:[2,3,0,1] row_mask:0xf bank_mask:0xf
  v_add_f32_dpp v12, v12, v12 quad_perm:[2,3,0,1] row_mask:0xf bank_mask:0xf
  s_nop 1
  v_add_f32_dpp v10, v10, v10 row_half_mirror row_mask:0xf bank_mask:0xf
  v_add_f32_dpp v12, v12, v12 row_half_mirror row_mask:0xf bank_mask:0xf
  s_nop 1
  v_add_f32_dpp v10, v10, v10 row_mirror row_mask:0xf bank_mask:0xf
  v_add_f32_dpp v12, v12, v12 row_mirror row_mask:0xf bank_mask:0xf
  s_nop 1
  v_mov_b32 v11, v10
  v_mov_b32 v13, v12
  s_nop 1
  v_permlane16_swap_b32 v10, v11
  v_permlane16_swap_b32 v12, v13
  s_nop 1
  v_add_f32 v10, v10, v11
  v_add_f32 v12, v12, v13
  v_mov_b32 v11, v10
  v_mov_b32 v13, v12
  s_nop 1
  v_permlane32_swap_b32 v10, v11
  v_permlane32_swap_b32 v12, v13
  s_nop 1
  v_add_f32 v10, v10, v11
  v_add_f32 v12, v12, v13
  v_mul_f32 v10, 0x3a800000, v10
  v_mul_f32 v12, 0x3a800000, v12
  v_fma_f32 v12, -v10, v10, v12
  v_max_f32 v12, 0, v12
  v_add_f32 v12, 0x3727c5ac, v12
  v_rsq_f32 v12, v12
  v_sub_f32 v10, 0, v10
  v_pk_add_f32 v[176:177], v[176:177], v[10:11] op_sel:[0,0] op_sel_hi:[1,0]
  v_pk_add_f32 v[178:179], v[178:179], v[10:11] op_sel:[0,0] op_sel_hi:[1,0]
  v_pk_add_f32 v[180:181], v[180:181], v[10:11] op_sel:[0,0] op_sel_hi:[1,0]
  v_pk_add_f32 v[182:183], v[182:183], v[10:11] op_sel:[0,0] op_sel_hi:[1,0]
  v_pk_add_f32 v[184:185], v[184:185], v[10:11] op_sel:[0,0] op_sel_hi:[1,0]
  v_pk_add_f32 v[186:187], v[186:187], v[10:11] op_sel:[0,0] op_sel_hi:[1,0]
  v_pk_add_f32 v[188:189], v[188:189], v[10:11] op_sel:[0,0] op_sel_hi:[1,0]
  v_pk_add_f32 v[190:191], v[190:191], v[10:11] op_sel:[0,0] op_sel_hi:[1,0]
  v_pk_mul_f32 v[176:177], v[176:177], v[12:13] op_sel:[0,0] op_sel_hi:[1,0]
  v_pk_mul_f32 v[178:179], v[178:179], v[12:13] op_sel:[0,0] op_sel_hi:[1,0]
  v_pk_mul_f32 v[180:181], v[180:181], v[12:13] op_sel:[0,0] op_sel_hi:[1,0]
  v_pk_mul_f32 v[182:183], v[182:183], v[12:13] op_sel:[0,0] op_sel_hi:[1,0]
  v_pk_mul_f32 v[184:185], v[184:185], v[12:13] op_sel:[0,0] op_sel_hi:[1,0]
  v_pk_mul_f32 v[186:187], v[186:187], v[12:13] op_sel:[0,0] op_sel_hi:[1,0]
  v_pk_mul_f32 v[188:189], v[188:189], v[12:13] op_sel:[0,0] op_sel_hi:[1,0]
  v_pk_mul_f32 v[190:191], v[190:191], v[12:13] op_sel:[0,0] op_sel_hi:[1,0]
  v_pk_fma_f32 v[176:177], v[176:177], v[224:225], v[240:241]
  v_pk_fma_f32 v[178:179], v[178:179], v[226:227], v[242:243]
  v_pk_fma_f32 v[180:181], v[180:181], v[228:229], v[244:245]
  v_pk_fma_f32 v[182:183], v[182:183], v[230:231], v[246:247]
  v_pk_fma_f32 v[184:185], v[184:185], v[232:233], v[248:249]
  v_pk_fma_f32 v[186:187], v[186:187], v[234:235], v[250:251]
  v_pk_fma_f32 v[188:189], v[188:189], v[236:237], v[252:253]
  v_pk_fma_f32 v[190:191], v[190:191], v[238:239], v[254:255]
  v_cvt_pk_bf16_f32 v160, v176, v177
  v_cvt_pk_bf16_f32 v161, v178, v179
  v_cvt_pk_bf16_f32 v162, v180, v181
  v_cvt_pk_bf16_f32 v163, v182, v183
  v_cvt_pk_bf16_f32 v164, v184, v185
  v_cvt_pk_bf16_f32 v165, v186, v187
  v_cvt_pk_bf16_f32 v166, v188, v189
  v_cvt_pk_bf16_f32 v167, v190, v191
  ds_write_b128 v17, v[160:163]
  ds_write_b128 v17, v[164:167] offset:256
  s_waitcnt lgkmcnt(0)
  s_barrier
  ds_read_b128 v[168:171], v22
  ds_read_b128 v[172:175], v22 offset:1056
  s_add_u32 s42, s41, 32768
  s_waitcnt lgkmcnt(1)
  buffer_store_dwordx4 v[168:171], v23, s[24:27], s41 offen sc1
  s_waitcnt lgkmcnt(0)
  buffer_store_dwordx4 v[172:175], v23, s[24:27], s42 offen sc1
  s_add_u32 s60, s32, 0x88800
  s_addc_u32 s61, s33, 0
  s_mov_b32 s62, 0x400
  s_mov_b32 s63, 0x20000
  s_waitcnt vmcnt(0) lgkmcnt(0)
  s_barrier
  s_cmp_lg_u32 s28, 0
  s_cbranch_scc1 kc_kernel_nosig
  s_lshr_b32 s38, s34, 8
  s_sub_u32 s39, 2045, s34
  s_lshr_b32 s39, s39, 8
  s_sub_u32 s40, 2048, s34
  s_cmp_eq_u32 s34, 0
  s_cselect_b32 s40, 1024, s40
  s_lshr_b32 s40, s40, 8
  s_cmp_eq_u32 s40, s39
  s_cselect_b32 s40, 64, s40
  v_mov_b32 v20, 1
  v_mov_b32 v21, s38
  v_writelane_b32 v21, s39, 1
  v_writelane_b32 v21, s40, 2
  v_lshlrev_b32 v21, 7, v21
  s_mov_b64 exec, 7
  buffer_atomic_add v20, v21, s[60:63], 0 offen sc1
  s_mov_b64 exec, -1
kc_kernel_nosig:
  s_load_dwordx2 s[4:5], s[0:1], 48
  s_load_dwordx2 s[6:7], s[0:1], 56
  s_load_dwordx2 s[30:31], s[0:1], 64
  s_and_b32 s34, s2, 7
  s_lshr_b32 s35, s2, 3
  s_and_b32 s36, s34, 1
  s_lshl_b32 s36, s36, 2
  s_and_b32 s37, s35, 3
  s_add_u32 s36, s36, s37
  s_lshr_b32 s37, s34, 1
  s_lshl_b32 s37, s37, 3
  s_lshr_b32 s38, s35, 2
  s_add_u32 s37, s37, s38
  v_lshrrev_b32 v16, 4, v0
  v_and_b32 v17, 1, v16
  v_lshlrev_b32 v17, 4, v17
  v_lshrrev_b32 v18, 1, v16
  v_lshlrev_b32 v18, 2, v18
  v_add_u32 v17, v17, v18
  s_lshr_b32 s39, s28, 2
  s_lshl_b32 s39, s39, 3
  s_and_b32 s40, s28, 3
  s_add_u32 s39, s39, s40
  v_add_u32 v17, s39, v17
  s_mov_b32 s41, 7168
  v_mul_lo_u32 v17, v17, s41
  v_and_b32 v18, 15, v0
  v_lshlrev_b32 v19, 4, v18
  v_add_u32 v1, v17, v19
  v_cmp_lt_u32 vcc, 13, v18
  v_bfrev_b32 v19, 1
  s_nop 0
  v_cndmask_b32 v1, v1, v19, vcc
  s_lshl_b32 s39, s28, 11
  v_lshlrev_b32 v3, 4, v0
  v_add_u32 v2, s39, v3
  s_mul_i32 s26, s28, 4128
  s_mul_i32 s39, s37, 224
  s_sub_u32 s40, 7340032, s39
  s_lshl_b32 s42, s36, 19
  s_waitcnt lgkmcnt(0)
  s_add_u32 s8, s4, s39
  s_addc_u32 s9, s5, 0
  s_mov_b32 s10, s40
  s_mov_b32 s11, 0x20000
  s_add_u32 s12, s6, s39
  s_addc_u32 s13, s7, 0
  s_mov_b32 s14, s40
  s_mov_b32 s15, 0x20000
  s_add_u32 s16, s32, s42
  s_addc_u32 s17, s33, 0
  s_add_u32 s16, s16, 0x1100000
  s_addc_u32 s17, s17, 0
  s_mov_b32 s18, 0x80000
  s_mov_b32 s19, 0x20000
  s_mov_b32 s24, 0
  s_mov_b32 s25, 0
  s_add_u32 m0, s26, 0
  s_nop 0
  buffer_load_dwordx4 v1, s[8:11], s24 offen lds
  s_add_u32 m0, s26, 1024
  s_nop 0
  buffer_load_dwordx4 v1, s[12:15], s24 offen lds
  s_add_u32 s24, s24, 229376
  s_add_u32 m0, s26, 33024
  s_nop 0
  buffer_load_dwordx4 v1, s[8:11], s24 offen lds
  s_add_u32 m0, s26, 34048
  s_nop 0
  buffer_load_dwordx4 v1, s[12:15], s24 offen lds
  s_add_u32 s24, s24, 229376
  s_add_u32 m0, s26, 66048
  s_nop 0
  buffer_load_dwordx4 v1, s[8:11], s24 offen lds
  s_add_u32 m0, s26, 67072
  s_nop 0
  buffer_load_dwordx4 v1, s[12:15], s24 offen lds
  s_add_u32 s24, s24, 229376
  v_and_b32 v17, 1, v16
  v_lshlrev_b32 v17, 2, v17
  v_bfe_u32 v18, v0, 2, 2
  v_add_u32 v17, v17, v18
  s_mov_b32 s41, 4128
  v_mul_lo_u32 v17, v17, s41
  v_lshrrev_b32 v18, 1, v16
  v_lshlrev_b32 v18, 8, v18
  v_add_u32 v17, v17, v18
  v_and_b32 v18, 3, v0
  v_lshlrev_b32 v18, 3, v18
  v_add_u32 v4, v17, v18
  s_and_b32 s39, s28, 3
  s_mul_i32 s39, s39, 8256
  s_add_u32 s39, s39, 2048
  v_add_u32 v10, s39, v3
  v_mov_b32 v24, 0
  v_mov_b32 v25, 0
  v_mov_b32 v26, 0
  v_mov_b32 v27, 0
  s_cmp_lg_u32 s28, 0
  s_cbranch_scc1 g3_nodep
  s_lshl_b32 s38, s36, 7
  v_mov_b32 v21, s38
  s_cmp_ge_u32 s36, 4
  s_cselect_b32 s39, 65, 64
  s_mov_b32 s46, 0x100000
g3_dep:
  buffer_load_dword v22, v21, s[60:63], 0 offen sc1
  s_waitcnt vmcnt(0)
  v_readfirstlane_b32 s47, v22
  s_cmp_ge_u32 s47, s39
  s_cbranch_scc1 g3_nodep
  s_sub_u32 s46, s46, 1
  s_cmp_lg_u32 s46, 0
  s_cbranch_scc0 g3_nodep
  s_sleep 1
  s_branch g3_dep
g3_nodep:
  s_barrier
  s_add_u32 m0, s26, 2048
  s_nop 0
  buffer_load_dwordx4 v2, s[16:19], s25 offen sc1 lds
  buffer_load_dwordx4 v2, s[16:19], s25 offen offset:1024 sc1 lds
  s_add_u32 s25, s25, 16384
  s_add_u32 m0, s26, 35072
  s_nop 0
  buffer_load_dwordx4 v2, s[16:19], s25 offen sc1 lds
  buffer_load_dwordx4 v2, s[16:19], s25 offen offset:1024 sc1 lds
  s_add_u32 s25, s25, 16384
  s_add_u32 m0, s26, 68096
  s_nop 0
  buffer_load_dwordx4 v2, s[16:19], s25 offen sc1 lds
  buffer_load_dwordx4 v2, s[16:19], s25 offen offset:1024 sc1 lds
  s_add_u32 s25, s25, 16384
  v_mfma_f32_32x32x16_bf16 v[128:143], v[24:27], v[24:27], 0
  v_mfma_f32_32x32x16_bf16 v[144:159], v[24:27], v[24:27], 0
  v_mfma_f32_32x32x16_bf16 v[160:175], v[24:27], v[24:27], 0
  v_mfma_f32_32x32x16_bf16 v[176:191], v[24:27], v[24:27], 0
  v_mfma_f32_32x32x16_bf16 v[192:207], v[24:27], v[24:27], 0
  v_mfma_f32_32x32x16_bf16 v[208:223], v[24:27], v[24:27], 0
  v_mfma_f32_32x32x16_bf16 v[224:239], v[24:27], v[24:27], 0
  v_mfma_f32_32x32x16_bf16 v[240:255], v[24:27], v[24:27], 0
  s_and_b32 s39, s37, 1
  s_cmp_eq_u32 s39, 0
  s_cselect_b32 s40, 0, 96
  s_cselect_b32 s41, 128, 32
  s_cselect_b32 s42, 192, 0
  s_cmp_ge_u32 s28, 4
  s_cselect_b32 s40, s41, s40
  v_add_u32 v20, s42, v4
  v_add_u32 v4, s40, v4
  v_add_u32 v5, 33024, v4
  v_add_u32 v21, 33024, v20
  v_add_u32 v11, 33024, v10
  v_add_u32 v6, 66048, v4
  v_add_u32 v22, 66048, v20
  v_add_u32 v12, 66048, v10
  v_add_u32 v7, 99072, v4
  v_add_u32 v23, 99072, v20
  v_add_u32 v13, 99072, v10
  v_lshlrev_b32 v30, 6, v30
  s_add_u32 s20, s32, 0x1500000
  s_addc_u32 s21, s33, 0
  s_mov_b32 s22, 0xe00000
  s_mov_b32 s23, 0x20000
  s_mul_i32 s39, s2, 28672
  s_add_u32 s44, s30, s39
  s_addc_u32 s45, s31, 0
  s_mov_b32 s46, 0x7000
  s_mov_b32 s47, 0x20000
  s_waitcnt vmcnt(2)
  s_barrier
  s_cmp_ge_u32 s28, 4
  s_cbranch_scc1 g3_typeB
  ds_read_b128 v[64:67], v10 offset:0
  ds_read_b64_tr_b16 v[32:33], v4 offset:0
  ds_read_b64_tr_b16 v[34:35], v4 offset:512
  ds_read_b64_tr_b16 v[36:37], v4 offset:32
  ds_read_b64_tr_b16 v[38:39], v4 offset:544
  ds_read_b128 v[68:71], v10 offset:1024
  ds_read_b64_tr_b16 v[40:41], v4 offset:64
  ds_read_b64_tr_b16 v[42:43], v4 offset:576
  ds_read_b64_tr_b16 v[44:45], v4 offset:96
  ds_read_b64_tr_b16 v[46:47], v4 offset:608
  ds_read_b128 v[72:75], v10 offset:4128
  ds_read_b64_tr_b16 v[48:49], v4 offset:1024
  ds_read_b64_tr_b16 v[50:51], v4 offset:1536
  ds_read_b64_tr_b16 v[52:53], v4 offset:1056
  ds_read_b64_tr_b16 v[54:55], v4 offset:1568
  ds_read_b128 v[76:79], v10 offset:5152
  ds_read_b64_tr_b16 v[56:57], v4 offset:1088
  ds_read_b64_tr_b16 v[58:59], v4 offset:1600
  ds_read_b64_tr_b16 v[60:61], v4 offset:1120
  ds_read_b64_tr_b16 v[62:63], v4 offset:1632
  s_add_u32 m0, s26, 99072
  s_nop 0
  buffer_load_dwordx4 v1, s[8:11], s24 offen lds
  s_add_u32 m0, s26, 100096
  s_nop 0
  buffer_load_dwordx4 v1, s[12:15], s24 offen lds
  s_add_u32 m0, s26, 101120
  s_nop 0
  buffer_load_dwordx4 v2, s[16:19], s25 offen sc1 lds
  buffer_load_dwordx4 v2, s[16:19], s25 offen offset:1024 sc1 lds
  s_add_u32 s24, s24, 229376
  s_add_u32 s25, s25, 16384
  s_mov_b32 s27, 7
g3_loop0:
  s_waitcnt vmcnt(8) lgkmcnt(0)
  s_barrier
  v_mfma_f32_16x16x32_bf16 v[128:131], v[32:35], v[64:67], v[128:131]
  ds_read_b128 v[112:115], v11 offset:0
  ds_read_b64_tr_b16 v[80:81], v5 offset:0
  v_mfma_f32_16x16x32_bf16 v[132:135], v[36:39], v[64:67], v[132:135]
  ds_read_b64_tr_b16 v[82:83], v5 offset:512
  v_mfma_f32_16x16x32_bf16 v[136:139], v[40:43], v[64:67], v[136:139]
  ds_read_b64_tr_b16 v[84:85], v5 offset:32
  s_add_u32 m0, s26, 0
  v_mfma_f32_16x16x32_bf16 v[140:143], v[44:47], v[64:67], v[140:143]
  ds_read_b64_tr_b16 v[86:87], v5 offset:544
  buffer_load_dwordx4 v1, s[8:11], s24 offen lds
  v_mfma_f32_16x16x32_bf16 v[144:147], v[48:51], v[64:67], v[144:147]
  ds_read_b128 v[116:119], v11 offset:1024
  v_mfma_f32_16x16x32_bf16 v[148:151], v[52:55], v[64:67], v[148:151]
  ds_read_b64_tr_b16 v[88:89], v5 offset:64
  v_mfma_f32_16x16x32_bf16 v[152:155], v[56:59], v[64:67], v[152:155]
  ds_read_b64_tr_b16 v[90:91], v5 offset:576
  v_mfma_f32_16x16x32_bf16 v[156:159], v[60:63], v[64:67], v[156:159]
  ds_read_b64_tr_b16 v[92:93], v5 offset:96
  v_mfma_f32_16x16x32_bf16 v[160:163], v[32:35], v[68:71], v[160:163]
  ds_read_b64_tr_b16 v[94:95], v5 offset:608
  v_mfma_f32_16x16x32_bf16 v[164:167], v[36:39], v[68:71], v[164:167]
  ds_read_b128 v[120:123], v11 offset:4128
  v_mfma_f32_16x16x32_bf16 v[168:171], v[40:43], v[68:71], v[168:171]
  ds_read_b64_tr_b16 v[96:97], v5 offset:1024
  s_add_u32 m0, s26, 1024
  v_mfma_f32_16x16x32_bf16 v[172:175], v[44:47], v[68:71], v[172:175]
  ds_read_b64_tr_b16 v[98:99], v5 offset:1536
  buffer_load_dwordx4 v1, s[12:15], s24 offen lds
  v_mfma_f32_16x16x32_bf16 v[176:179], v[48:51], v[68:71], v[176:179]
  ds_read_b64_tr_b16 v[100:101], v5 offset:1056
  v_mfma_f32_16x16x32_bf16 v[180:183], v[52:55], v[68:71], v[180:183]
  ds_read_b64_tr_b16 v[102:103], v5 offset:1568
  v_mfma_f32_16x16x32_bf16 v[184:187], v[56:59], v[68:71], v[184:187]
  ds_read_b128 v[124:127], v11 offset:5152
  v_mfma_f32_16x16x32_bf16 v[188:191], v[60:63], v[68:71], v[188:191]
  ds_read_b64_tr_b16 v[104:105], v5 offset:1088
  v_mfma_f32_16x16x32_bf16 v[192:195], v[32:35], v[72:75], v[192:195]
  ds_read_b64_tr_b16 v[106:107], v5 offset:1600
  v_mfma_f32_16x16x32_bf16 v[196:199], v[36:39], v[72:75], v[196:199]
  ds_read_b64_tr_b16 v[108:109], v5 offset:1120
  v_mfma_f32_16x16x32_bf16 v[200:203], v[40:43], v[72:75], v[200:203]
  ds_read_b64_tr_b16 v[110:111], v5 offset:1632
  s_add_u32 m0, s26, 2048
  v_mfma_f32_16x16x32_bf16 v[204:207], v[44:47], v[72:75], v[204:207]
  buffer_load_dwordx4 v2, s[16:19], s25 offen sc1 lds
  v_mfma_f32_16x16x32_bf16 v[208:211], v[48:51], v[72:75], v[208:211]
  v_mfma_f32_16x16x32_bf16 v[212:215], v[52:55], v[72:75], v[212:215]
  v_mfma_f32_16x16x32_bf16 v[216:219], v[56:59], v[72:75], v[216:219]
  v_mfma_f32_16x16x32_bf16 v[220:223], v[60:63], v[72:75], v[220:223]
  v_mfma_f32_16x16x32_bf16 v[224:227], v[32:35], v[76:79], v[224:227]
  v_mfma_f32_16x16x32_bf16 v[228:231], v[36:39], v[76:79], v[228:231]
  v_mfma_f32_16x16x32_bf16 v[232:235], v[40:43], v[76:79], v[232:235]
  v_mfma_f32_16x16x32_bf16 v[236:239], v[44:47], v[76:79], v[236:239]
  buffer_load_dwordx4 v2, s[16:19], s25 offen offset:1024 sc1 lds
  s_add_u32 s24, s24, 229376
  s_add_u32 s25, s25, 16384
  v_mfma_f32_16x16x32_bf16 v[240:243], v[48:51], v[76:79], v[240:243]
  v_mfma_f32_16x16x32_bf16 v[244:247], v[52:55], v[76:79], v[244:247]
  v_mfma_f32_16x16x32_bf16 v[248:251], v[56:59], v[76:79], v[248:251]
  v_mfma_f32_16x16x32_bf16 v[252:255], v[60:63], v[76:79], v[252:255]
  s_waitcnt vmcnt(8) lgkmcnt(0)
  s_barrier
  v_mfma_f32_16x16x32_bf16 v[128:131], v[80:83], v[112:115], v[128:131]
  ds_read_b128 v[64:67], v12 offset:0
  ds_read_b64_tr_b16 v[32:33], v6 offset:0
  v_mfma_f32_16x16x32_bf16 v[132:135], v[84:87], v[112:115], v[132:135]
  ds_read_b64_tr_b16 v[34:35], v6 offset:512
  v_mfma_f32_16x16x32_bf16 v[136:139], v[88:91], v[112:115], v[136:139]
  ds_read_b64_tr_b16 v[36:37], v6 offset:32
  s_add_u32 m0, s26, 33024
  v_mfma_f32_16x16x32_bf16 v[140:143], v[92:95], v[112:115], v[140:143]
  ds_read_b64_tr_b16 v[38:39], v6 offset:544
  buffer_load_dwordx4 v1, s[8:11], s24 offen lds
  v_mfma_f32_16x16x32_bf16 v[144:147], v[96:99], v[112:115], v[144:147]
  ds_read_b128 v[68:71], v12 offset:1024
  v_mfma_f32_16x16x32_bf16 v[148:151], v[100:103], v[112:115], v[148:151]
  ds_read_b64_tr_b16 v[40:41], v6 offset:64
  v_mfma_f32_16x16x32_bf16 v[152:155], v[104:107], v[112:115], v[152:155]
  ds_read_b64_tr_b16 v[42:43], v6 offset:576
  v_mfma_f32_16x16x32_bf16 v[156:159], v[108:111], v[112:115], v[156:159]
  ds_read_b64_tr_b16 v[44:45], v6 offset:96
  v_mfma_f32_16x16x32_bf16 v[160:163], v[80:83], v[116:119], v[160:163]
  ds_read_b64_tr_b16 v[46:47], v6 offset:608
  v_mfma_f32_16x16x32_bf16 v[164:167], v[84:87], v[116:119], v[164:167]
  ds_read_b128 v[72:75], v12 offset:4128
  v_mfma_f32_16x16x32_bf16 v[168:171], v[88:91], v[116:119], v[168:171]
  ds_read_b64_tr_b16 v[48:49], v6 offset:1024
  s_add_u32 m0, s26, 34048
  v_mfma_f32_16x16x32_bf16 v[172:175], v[92:95], v[116:119], v[172:175]
  ds_read_b64_tr_b16 v[50:51], v6 offset:1536
  buffer_load_dwordx4 v1, s[12:15], s24 offen lds
  v_mfma_f32_16x16x32_bf16 v[176:179], v[96:99], v[116:119], v[176:179]
  ds_read_b64_tr_b16 v[52:53], v6 offset:1056
  v_mfma_f32_16x16x32_bf16 v[180:183], v[100:103], v[116:119], v[180:183]
  ds_read_b64_tr_b16 v[54:55], v6 offset:1568
  v_mfma_f32_16x16x32_bf16 v[184:187], v[104:107], v[116:119], v[184:187]
  ds_read_b128 v[76:79], v12 offset:5152
  v_mfma_f32_16x16x32_bf16 v[188:191], v[108:111], v[116:119], v[188:191]
  ds_read_b64_tr_b16 v[56:57], v6 offset:1088
  v_mfma_f32_16x16x32_bf16 v[192:195], v[80:83], v[120:123], v[192:195]
  ds_read_b64_tr_b16 v[58:59], v6 offset:1600
  v_mfma_f32_16x16x32_bf16 v[196:199], v[84:87], v[120:123], v[196:199]
  ds_read_b64_tr_b16 v[60:61], v6 offset:1120
  v_mfma_f32_16x16x32_bf16 v[200:203], v[88:91], v[120:123], v[200:203]
  ds_read_b64_tr_b16 v[62:63], v6 offset:1632
  s_add_u32 m0, s26, 35072
  v_mfma_f32_16x16x32_bf16 v[204:207], v[92:95], v[120:123], v[204:207]
  buffer_load_dwordx4 v2, s[16:19], s25 offen sc1 lds
  v_mfma_f32_16x16x32_bf16 v[208:211], v[96:99], v[120:123], v[208:211]
  v_mfma_f32_16x16x32_bf16 v[212:215], v[100:103], v[120:123], v[212:215]
  v_mfma_f32_16x16x32_bf16 v[216:219], v[104:107], v[120:123], v[216:219]
  v_mfma_f32_16x16x32_bf16 v[220:223], v[108:111], v[120:123], v[220:223]
  v_mfma_f32_16x16x32_bf16 v[224:227], v[80:83], v[124:127], v[224:227]
  v_mfma_f32_16x16x32_bf16 v[228:231], v[84:87], v[124:127], v[228:231]
  v_mfma_f32_16x16x32_bf16 v[232:235], v[88:91], v[124:127], v[232:235]
  v_mfma_f32_16x16x32_bf16 v[236:239], v[92:95], v[124:127], v[236:239]
  buffer_load_dwordx4 v2, s[16:19], s25 offen offset:1024 sc1 lds
  s_add_u32 s24, s24, 229376
  s_add_u32 s25, s25, 16384
  v_mfma_f32_16x16x32_bf16 v[240:243], v[96:99], v[124:127], v[240:243]
  v_mfma_f32_16x16x32_bf16 v[244:247], v[100:103], v[124:127], v[244:247]
  v_mfma_f32_16x16x32_bf16 v[248:251], v[104:107], v[124:127], v[248:251]
  v_mfma_f32_16x16x32_bf16 v[252:255], v[108:111], v[124:127], v[252:255]
  s_waitcnt vmcnt(8) lgkmcnt(0)
  s_barrier
  v_mfma_f32_16x16x32_bf16 v[128:131], v[32:35], v[64:67], v[128:131]
  ds_read_b128 v[112:115], v13 offset:0
  ds_read_b64_tr_b16 v[80:81], v7 offset:0
  v_mfma_f32_16x16x32_bf16 v[132:135], v[36:39], v[64:67], v[132:135]
  ds_read_b64_tr_b16 v[82:83], v7 offset:512
  v_mfma_f32_16x16x32_bf16 v[136:139], v[40:43], v[64:67], v[136:139]
  ds_read_b64_tr_b16 v[84:85], v7 offset:32
  s_add_u32 m0, s26, 66048
  v_mfma_f32_16x16x32_bf16 v[140:143], v[44:47], v[64:67], v[140:143]
  ds_read_b64_tr_b16 v[86:87], v7 offset:544
  buffer_load_dwordx4 v1, s[8:11], s24 offen lds
  v_mfma_f32_16x16x32_bf16 v[144:147], v[48:51], v[64:67], v[144:147]
  ds_read_b128 v[116:119], v13 offset:1024
  v_mfma_f32_16x16x32_bf16 v[148:151], v[52:55], v[64:67], v[148:151]
  ds_read_b64_tr_b16 v[88:89], v7 offset:64
  v_mfma_f32_16x16x32_bf16 v[152:155], v[56:59], v[64:67], v[152:155]
  ds_read_b64_tr_b16 v[90:91], v7 offset:576
  v_mfma_f32_16x16x32_bf16 v[156:159], v[60:63], v[64:67], v[156:159]
  ds_read_b64_tr_b16 v[92:93], v7 offset:96
  v_mfma_f32_16x16x32_bf16 v[160:163], v[32:35], v[68:71], v[160:163]
  ds_read_b64_tr_b16 v[94:95], v7 offset:608
  v_mfma_f32_16x16x32_bf16 v[164:167], v[36:39], v[68:71], v[164:167]
  ds_read_b128 v[120:123], v13 offset:4128
  v_mfma_f32_16x16x32_bf16 v[168:171], v[40:43], v[68:71], v[168:171]
  ds_read_b64_tr_b16 v[96:97], v7 offset:1024
  s_add_u32 m0, s26, 67072
  v_mfma_f32_16x16x32_bf16 v[172:175], v[44:47], v[68:71], v[172:175]
  ds_read_b64_tr_b16 v[98:99], v7 offset:1536
  buffer_load_dwordx4 v1, s[12:15], s24 offen lds
  v_mfma_f32_16x16x32_bf16 v[176:179], v[48:51], v[68:71], v[176:179]
  ds_read_b64_tr_b16 v[100:101], v7 offset:1056
  v_mfma_f32_16x16x32_bf16 v[180:183], v[52:55], v[68:71], v[180:183]
  ds_read_b64_tr_b16 v[102:103], v7 offset:1568
  v_mfma_f32_16x16x32_bf16 v[184:187], v[56:59], v[68:71], v[184:187]
  ds_read_b128 v[124:127], v13 offset:5152
  v_mfma_f32_16x16x32_bf16 v[188:191], v[60:63], v[68:71], v[188:191]
  ds_read_b64_tr_b16 v[104:105], v7 offset:1088
  v_mfma_f32_16x16x32_bf16 v[192:195], v[32:35], v[72:75], v[192:195]
  ds_read_b64_tr_b16 v[106:107], v7 offset:1600
  v_mfma_f32_16x16x32_bf16 v[196:199], v[36:39], v[72:75], v[196:199]
  ds_read_b64_tr_b16 v[108:109], v7 offset:1120
  v_mfma_f32_16x16x32_bf16 v[200:203], v[40:43], v[72:75], v[200:203]
  ds_read_b64_tr_b16 v[110:111], v7 offset:1632
  s_add_u32 m0, s26, 68096
  v_mfma_f32_16x16x32_bf16 v[204:207], v[44:47], v[72:75], v[204:207]
  buffer_load_dwordx4 v2, s[16:19], s25 offen sc1 lds
  v_mfma_f32_16x16x32_bf16 v[208:211], v[48:51], v[72:75], v[208:211]
  v_mfma_f32_16x16x32_bf16 v[212:215], v[52:55], v[72:75], v[212:215]
  v_mfma_f32_16x16x32_bf16 v[216:219], v[56:59], v[72:75], v[216:219]
  v_mfma_f32_16x16x32_bf16 v[220:223], v[60:63], v[72:75], v[220:223]
  v_mfma_f32_16x16x32_bf16 v[224:227], v[32:35], v[76:79], v[224:227]
  v_mfma_f32_16x16x32_bf16 v[228:231], v[36:39], v[76:79], v[228:231]
  v_mfma_f32_16x16x32_bf16 v[232:235], v[40:43], v[76:79], v[232:235]
  v_mfma_f32_16x16x32_bf16 v[236:239], v[44:47], v[76:79], v[236:239]
  buffer_load_dwordx4 v2, s[16:19], s25 offen offset:1024 sc1 lds
  s_add_u32 s24, s24, 229376
  s_add_u32 s25, s25, 16384
  v_mfma_f32_16x16x32_bf16 v[240:243], v[48:51], v[76:79], v[240:243]
  v_mfma_f32_16x16x32_bf16 v[244:247], v[52:55], v[76:79], v[244:247]
  v_mfma_f32_16x16x32_bf16 v[248:251], v[56:59], v[76:79], v[248:251]
  v_mfma_f32_16x16x32_bf16 v[252:255], v[60:63], v[76:79], v[252:255]
  s_waitcnt vmcnt(8) lgkmcnt(0)
  s_barrier
  v_mfma_f32_16x16x32_bf16 v[128:131], v[80:83], v[112:115], v[128:131]
  ds_read_b128 v[64:67], v10 offset:0
  ds_read_b64_tr_b16 v[32:33], v4 offset:0
  v_mfma_f32_16x16x32_bf16 v[132:135], v[84:87], v[112:115], v[132:135]
  ds_read_b64_tr_b16 v[34:35], v4 offset:512
  v_mfma_f32_16x16x32_bf16 v[136:139], v[88:91], v[112:115], v[136:139]
  ds_read_b64_tr_b16 v[36:37], v4 offset:32
  s_add_u32 m0, s26, 99072
  v_mfma_f32_16x16x32_bf16 v[140:143], v[92:95], v[112:115], v[140:143]
  ds_read_b64_tr_b16 v[38:39], v4 offset:544
  buffer_load_dwordx4 v1, s[8:11], s24 offen lds
  v_mfma_f32_16x16x32_bf16 v[144:147], v[96:99], v[112:115], v[144:147]
  ds_read_b128 v[68:71], v10 offset:1024
  v_mfma_f32_16x16x32_bf16 v[148:151], v[100:103], v[112:115], v[148:151]
  ds_read_b64_tr_b16 v[40:41], v4 offset:64
  v_mfma_f32_16x16x32_bf16 v[152:155], v[104:107], v[112:115], v[152:155]
  ds_read_b64_tr_b16 v[42:43], v4 offset:576
  v_mfma_f32_16x16x32_bf16 v[156:159], v[108:111], v[112:115], v[156:159]
  ds_read_b64_tr_b16 v[44:45], v4 offset:96
  v_mfma_f32_16x16x32_bf16 v[160:163], v[80:83], v[116:119], v[160:163]
  ds_read_b64_tr_b16 v[46:47], v4 offset:608
  v_mfma_f32_16x16x32_bf16 v[164:167], v[84:87], v[116:119], v[164:167]
  ds_read_b128 v[72:75], v10 offset:4128
  v_mfma_f32_16x16x32_bf16 v[168:171], v[88:91], v[116:119], v[168:171]
  ds_read_b64_tr_b16 v[48:49], v4 offset:1024
  s_add_u32 m0, s26, 100096
  v_mfma_f32_16x16x32_bf16 v[172:175], v[92:95], v[116:119], v[172:175]
  ds_read_b64_tr_b16 v[50:51], v4 offset:1536
  buffer_load_dwordx4 v1, s[12:15], s24 offen lds
  v_mfma_f32_16x16x32_bf16 v[176:179], v[96:99], v[116:119], v[176:179]
  ds_read_b64_tr_b16 v[52:53], v4 offset:1056
  v_mfma_f32_16x16x32_bf16 v[180:183], v[100:103], v[116:119], v[180:183]
  ds_read_b64_tr_b16 v[54:55], v4 offset:1568
  v_mfma_f32_16x16x32_bf16 v[184:187], v[104:107], v[116:119], v[184:187]
  ds_read_b128 v[76:79], v10 offset:5152
  v_mfma_f32_16x16x32_bf16 v[188:191], v[108:111], v[116:119], v[188:191]
  ds_read_b64_tr_b16 v[56:57], v4 offset:1088
  v_mfma_f32_16x16x32_bf16 v[192:195], v[80:83], v[120:123], v[192:195]
  ds_read_b64_tr_b16 v[58:59], v4 offset:1600
  v_mfma_f32_16x16x32_bf16 v[196:199], v[84:87], v[120:123], v[196:199]
  ds_read_b64_tr_b16 v[60:61], v4 offset:1120
  v_mfma_f32_16x16x32_bf16 v[200:203], v[88:91], v[120:123], v[200:203]
  ds_read_b64_tr_b16 v[62:63], v4 offset:1632
  s_add_u32 m0, s26, 101120
  v_mfma_f32_16x16x32_bf16 v[204:207], v[92:95], v[120:123], v[204:207]
  buffer_load_dwordx4 v2, s[16:19], s25 offen sc1 lds
  v_mfma_f32_16x16x32_bf16 v[208:211], v[96:99], v[120:123], v[208:211]
  v_mfma_f32_16x16x32_bf16 v[212:215], v[100:103], v[120:123], v[212:215]
  v_mfma_f32_16x16x32_bf16 v[216:219], v[104:107], v[120:123], v[216:219]
  v_mfma_f32_16x16x32_bf16 v[220:223], v[108:111], v[120:123], v[220:223]
  v_mfma_f32_16x16x32_bf16 v[224:227], v[80:83], v[124:127], v[224:227]
  v_mfma_f32_16x16x32_bf16 v[228:231], v[84:87], v[124:127], v[228:231]
  v_mfma_f32_16x16x32_bf16 v[232:235], v[88:91], v[124:127], v[232:235]
  v_mfma_f32_16x16x32_bf16 v[236:239], v[92:95], v[124:127], v[236:239]
  buffer_load_dwordx4 v2, s[16:19], s25 offen offset:1024 sc1 lds
  s_add_u32 s24, s24, 229376
  s_add_u32 s25, s25, 16384
  v_mfma_f32_16x16x32_bf16 v[240:243], v[96:99], v[124:127], v[240:243]
  v_mfma_f32_16x16x32_bf16 v[244:247], v[100:103], v[124:127], v[244:247]
  v_mfma_f32_16x16x32_bf16 v[248:251], v[104:107], v[124:127], v[248:251]
  v_mfma_f32_16x16x32_bf16 v[252:255], v[108:111], v[124:127], v[252:255]
  s_sub_u32 s27, s27, 1
  s_cmp_lg_u32 s27, 0
  s_cbranch_scc1 g3_loop0
  s_waitcnt vmcnt(8) lgkmcnt(0)
  s_barrier
  v_mfma_f32_16x16x32_bf16 v[128:131], v[32:35], v[64:67], v[128:131]
  ds_read_b128 v[112:115], v11 offset:0
  ds_read_b64_tr_b16 v[80:81], v5 offset:0
  v_mfma_f32_16x16x32_bf16 v[132:135], v[36:39], v[64:67], v[132:135]
  ds_read_b64_tr_b16 v[82:83], v5 offset:512
  v_mfma_f32_16x16x32_bf16 v[136:139], v[40:43], v[64:67], v[136:139]
  ds_read_b64_tr_b16 v[84:85], v5 offset:32
  v_mfma_f32_16x16x32_bf16 v[140:143], v[44:47], v[64:67], v[140:143]
  ds_read_b64_tr_b16 v[86:87], v5 offset:544
  v_mfma_f32_16x16x32_bf16 v[144:147], v[48:51], v[64:67], v[144:147]
  ds_read_b128 v[116:119], v11 offset:1024
  v_mfma_f32_16x16x32_bf16 v[148:151], v[52:55], v[64:67], v[148:151]
  ds_read_b64_tr_b16 v[88:89], v5 offset:64
  v_mfma_f32_16x16x32_bf16 v[152:155], v[56:59], v[64:67], v[152:155]
  ds_read_b64_tr_b16 v[90:91], v5 offset:576
  v_mfma_f32_16x16x32_bf16 v[156:159], v[60:63], v[64:67], v[156:159]
  ds_read_b64_tr_b16 v[92:93], v5 offset:96
  v_mfma_f32_16x16x32_bf16 v[160:163], v[32:35], v[68:71], v[160:163]
  ds_read_b64_tr_b16 v[94:95], v5 offset:608
  v_mfma_f32_16x16x32_bf16 v[164:167], v[36:39], v[68:71], v[164:167]
  ds_read_b128 v[120:123], v11 offset:4128
  v_mfma_f32_16x16x32_bf16 v[168:171], v[40:43], v[68:71], v[168:171]
  ds_read_b64_tr_b16 v[96:97], v5 offset:1024
  v_mfma_f32_16x16x32_bf16 v[172:175], v[44:47], v[68:71], v[172:175]
  ds_read_b64_tr_b16 v[98:99], v5 offset:1536
  v_mfma_f32_16x16x32_bf16 v[176:179], v[48:51], v[68:71], v[176:179]
  ds_read_b64_tr_b16 v[100:101], v5 offset:1056
  v_mfma_f32_16x16x32_bf16 v[180:183], v[52:55], v[68:71], v[180:183]
  ds_read_b64_tr_b16 v[102:103], v5 offset:1568
  v_mfma_f32_16x16x32_bf16 v[184:187], v[56:59], v[68:71], v[184:187]
  ds_read_b128 v[124:127], v11 offset:5152
  v_mfma_f32_16x16x32_bf16 v[188:191], v[60:63], v[68:71], v[188:191]
  ds_read_b64_tr_b16 v[104:105], v5 offset:1088
  v_mfma_f32_16x16x32_bf16 v[192:195], v[32:35], v[72:75], v[192:195]
  ds_read_b64_tr_b16 v[106:107], v5 offset:1600
  v_mfma_f32_16x16x32_bf16 v[196:199], v[36:39], v[72:75], v[196:199]
  ds_read_b64_tr_b16 v[108:109], v5 offset:1120
  v_mfma_f32_16x16x32_bf16 v[200:203], v[40:43], v[72:75], v[200:203]
  ds_read_b64_tr_b16 v[110:111], v5 offset:1632
  v_mfma_f32_16x16x32_bf16 v[204:207], v[44:47], v[72:75], v[204:207]
  v_mfma_f32_16x16x32_bf16 v[208:211], v[48:51], v[72:75], v[208:211]
  v_mfma_f32_16x16x32_bf16 v[212:215], v[52:55], v[72:75], v[212:215]
  v_mfma_f32_16x16x32_bf16 v[216:219], v[56:59], v[72:75], v[216:219]
  v_mfma_f32_16x16x32_bf16 v[220:223], v[60:63], v[72:75], v[220:223]
  v_mfma_f32_16x16x32_bf16 v[224:227], v[32:35], v[76:79], v[224:227]
  v_mfma_f32_16x16x32_bf16 v[228:231], v[36:39], v[76:79], v[228:231]
  v_mfma_f32_16x16x32_bf16 v[232:235], v[40:43], v[76:79], v[232:235]
  v_mfma_f32_16x16x32_bf16 v[236:239], v[44:47], v[76:79], v[236:239]
  v_mfma_f32_16x16x32_bf16 v[240:243], v[48:51], v[76:79], v[240:243]
  v_mfma_f32_16x16x32_bf16 v[244:247], v[52:55], v[76:79], v[244:247]
  v_mfma_f32_16x16x32_bf16 v[248:251], v[56:59], v[76:79], v[248:251]
  v_mfma_f32_16x16x32_bf16 v[252:255], v[60:63], v[76:79], v[252:255]
  s_waitcnt vmcnt(4) lgkmcnt(0)
  s_barrier
  v_mfma_f32_16x16x32_bf16 v[128:131], v[80:83], v[112:115], v[128:131]
  ds_read_b128 v[64:67], v12 offset:0
  ds_read_b64_tr_b16 v[32:33], v6 offset:0
  v_mfma_f32_16x16x32_bf16 v[132:135], v[84:87], v[112:115], v[132:135]
  ds_read_b64_tr_b16 v[34:35], v6 offset:512
  v_mfma_f32_16x16x32_bf16 v[136:139], v[88:91], v[112:115], v[136:139]
  ds_read_b64_tr_b16 v[36:37], v6 offset:32
  v_mfma_f32_16x16x32_bf16 v[140:143], v[92:95], v[112:115], v[140:143]
  ds_read_b64_tr_b16 v[38:39], v6 offset:544
  v_mfma_f32_16x16x32_bf16 v[144:147], v[96:99], v[112:115], v[144:147]
  ds_read_b128 v[68:71], v12 offset:1024
  v_mfma_f32_16x16x32_bf16 v[148:151], v[100:103], v[112:115], v[148:151]
  ds_read_b64_tr_b16 v[40:41], v6 offset:64
  v_mfma_f32_16x16x32_bf16 v[152:155], v[104:107], v[112:115], v[152:155]
  ds_read_b64_tr_b16 v[42:43], v6 offset:576
  v_mfma_f32_16x16x32_bf16 v[156:159], v[108:111], v[112:115], v[156:159]
  ds_read_b64_tr_b16 v[44:45], v6 offset:96
  v_mfma_f32_16x16x32_bf16 v[160:163], v[80:83], v[116:119], v[160:163]
  ds_read_b64_tr_b16 v[46:47], v6 offset:608
  v_mfma_f32_16x16x32_bf16 v[164:167], v[84:87], v[116:119], v[164:167]
  ds_read_b128 v[72:75], v12 offset:4128
  v_mfma_f32_16x16x32_bf16 v[168:171], v[88:91], v[116:119], v[168:171]
  ds_read_b64_tr_b16 v[48:49], v6 offset:1024
  v_mfma_f32_16x16x32_bf16 v[172:175], v[92:95], v[116:119], v[172:175]
  ds_read_b64_tr_b16 v[50:51], v6 offset:1536
  v_mfma_f32_16x16x32_bf16 v[176:179], v[96:99], v[116:119], v[176:179]
  ds_read_b64_tr_b16 v[52:53], v6 offset:1056
  v_mfma_f32_16x16x32_bf16 v[180:183], v[100:103], v[116:119], v[180:183]
  ds_read_b64_tr_b16 v[54:55], v6 offset:1568
  v_mfma_f32_16x16x32_bf16 v[184:187], v[104:107], v[116:119], v[184:187]
  ds_read_b128 v[76:79], v12 offset:5152
  v_mfma_f32_16x16x32_bf16 v[188:191], v[108:111], v[116:119], v[188:191]
  ds_read_b64_tr_b16 v[56:57], v6 offset:1088
  v_mfma_f32_16x16x32_bf16 v[192:195], v[80:83], v[120:123], v[192:195]
  ds_read_b64_tr_b16 v[58:59], v6 offset:1600
  v_mfma_f32_16x16x32_bf16 v[196:199], v[84:87], v[120:123], v[196:199]
  ds_read_b64_tr_b16 v[60:61], v6 offset:1120
  v_mfma_f32_16x16x32_bf16 v[200:203], v[88:91], v[120:123], v[200:203]
  ds_read_b64_tr_b16 v[62:63], v6 offset:1632
  v_mfma_f32_16x16x32_bf16 v[204:207], v[92:95], v[120:123], v[204:207]
  v_mfma_f32_16x16x32_bf16 v[208:211], v[96:99], v[120:123], v[208:211]
  v_mfma_f32_16x16x32_bf16 v[212:215], v[100:103], v[120:123], v[212:215]
  v_mfma_f32_16x16x32_bf16 v[216:219], v[104:107], v[120:123], v[216:219]
  v_mfma_f32_16x16x32_bf16 v[220:223], v[108:111], v[120:123], v[220:223]
  v_mfma_f32_16x16x32_bf16 v[224:227], v[80:83], v[124:127], v[224:227]
  v_mfma_f32_16x16x32_bf16 v[228:231], v[84:87], v[124:127], v[228:231]
  v_mfma_f32_16x16x32_bf16 v[232:235], v[88:91], v[124:127], v[232:235]
  v_mfma_f32_16x16x32_bf16 v[236:239], v[92:95], v[124:127], v[236:239]
  v_mfma_f32_16x16x32_bf16 v[240:243], v[96:99], v[124:127], v[240:243]
  v_mfma_f32_16x16x32_bf16 v[244:247], v[100:103], v[124:127], v[244:247]
  v_mfma_f32_16x16x32_bf16 v[248:251], v[104:107], v[124:127], v[248:251]
  v_mfma_f32_16x16x32_bf16 v[252:255], v[108:111], v[124:127], v[252:255]
  s_waitcnt vmcnt(0) lgkmcnt(0)
  s_barrier
  v_mfma_f32_16x16x32_bf16 v[128:131], v[32:35], v[64:67], v[128:131]
  ds_read_b128 v[112:115], v13 offset:0
  ds_read_b64_tr_b16 v[80:81], v7 offset:0
  v_mfma_f32_16x16x32_bf16 v[132:135], v[36:39], v[64:67], v[132:135]
  ds_read_b64_tr_b16 v[82:83], v7 offset:512
  v_mfma_f32_16x16x32_bf16 v[136:139], v[40:43], v[64:67], v[136:139]
  ds_read_b64_tr_b16 v[84:85], v7 offset:32
  v_mfma_f32_16x16x32_bf16 v[140:143], v[44:47], v[64:67], v[140:143]
  ds_read_b64_tr_b16 v[86:87], v7 offset:544
  v_mfma_f32_16x16x32_bf16 v[144:147], v[48:51], v[64:67], v[144:147]
  ds_read_b128 v[116:119], v13 offset:1024
  v_mfma_f32_16x16x32_bf16 v[148:151], v[52:55], v[64:67], v[148:151]
  ds_read_b64_tr_b16 v[88:89], v7 offset:64
  v_mfma_f32_16x16x32_bf16 v[152:155], v[56:59], v[64:67], v[152:155]
  ds_read_b64_tr_b16 v[90:91], v7 offset:576
  v_mfma_f32_16x16x32_bf16 v[156:159], v[60:63], v[64:67], v[156:159]
  ds_read_b64_tr_b16 v[92:93], v7 offset:96
  v_mfma_f32_16x16x32_bf16 v[160:163], v[32:35], v[68:71], v[160:163]
  ds_read_b64_tr_b16 v[94:95], v7 offset:608
  v_mfma_f32_16x16x32_bf16 v[164:167], v[36:39], v[68:71], v[164:167]
  ds_read_b128 v[120:123], v13 offset:4128
  v_mfma_f32_16x16x32_bf16 v[168:171], v[40:43], v[68:71], v[168:171]
  ds_read_b64_tr_b16 v[96:97], v7 offset:1024
  v_mfma_f32_16x16x32_bf16 v[172:175], v[44:47], v[68:71], v[172:175]
  ds_read_b64_tr_b16 v[98:99], v7 offset:1536
  v_mfma_f32_16x16x32_bf16 v[176:179], v[48:51], v[68:71], v[176:179]
  ds_read_b64_tr_b16 v[100:101], v7 offset:1056
  v_mfma_f32_16x16x32_bf16 v[180:183], v[52:55], v[68:71], v[180:183]
  ds_read_b64_tr_b16 v[102:103], v7 offset:1568
  v_mfma_f32_16x16x32_bf16 v[184:187], v[56:59], v[68:71], v[184:187]
  ds_read_b128 v[124:127], v13 offset:5152
  v_mfma_f32_16x16x32_bf16 v[188:191], v[60:63], v[68:71], v[188:191]
  ds_read_b64_tr_b16 v[104:105], v7 offset:1088
  v_mfma_f32_16x16x32_bf16 v[192:195], v[32:35], v[72:75], v[192:195]
  ds_read_b64_tr_b16 v[106:107], v7 offset:1600
  v_mfma_f32_16x16x32_bf16 v[196:199], v[36:39], v[72:75], v[196:199]
  ds_read_b64_tr_b16 v[108:109], v7 offset:1120
  v_mfma_f32_16x16x32_bf16 v[200:203], v[40:43], v[72:75], v[200:203]
  ds_read_b64_tr_b16 v[110:111], v7 offset:1632
  v_mfma_f32_16x16x32_bf16 v[204:207], v[44:47], v[72:75], v[204:207]
  v_mfma_f32_16x16x32_bf16 v[208:211], v[48:51], v[72:75], v[208:211]
  v_mfma_f32_16x16x32_bf16 v[212:215], v[52:55], v[72:75], v[212:215]
  v_mfma_f32_16x16x32_bf16 v[216:219], v[56:59], v[72:75], v[216:219]
  v_mfma_f32_16x16x32_bf16 v[220:223], v[60:63], v[72:75], v[220:223]
  v_mfma_f32_16x16x32_bf16 v[224:227], v[32:35], v[76:79], v[224:227]
  v_mfma_f32_16x16x32_bf16 v[228:231], v[36:39], v[76:79], v[228:231]
  v_mfma_f32_16x16x32_bf16 v[232:235], v[40:43], v[76:79], v[232:235]
  v_mfma_f32_16x16x32_bf16 v[236:239], v[44:47], v[76:79], v[236:239]
  v_mfma_f32_16x16x32_bf16 v[240:243], v[48:51], v[76:79], v[240:243]
  v_mfma_f32_16x16x32_bf16 v[244:247], v[52:55], v[76:79], v[244:247]
  v_mfma_f32_16x16x32_bf16 v[248:251], v[56:59], v[76:79], v[248:251]
  v_mfma_f32_16x16x32_bf16 v[252:255], v[60:63], v[76:79], v[252:255]
  s_waitcnt lgkmcnt(0)
  buffer_load_dword v31, v30, s[44:47], 0 offen
  s_and_b32 s39, s28, 3
  s_lshl_b32 s40, s36, 2
  s_add_u32 s39, s39, s40
  s_mul_i32 s39, s39, 458752
  s_mul_i32 s40, s37, 7
  s_and_b32 s41, s37, 1
  s_cmp_eq_u32 s41, 0
  s_cselect_b32 s41, 0, 3
  s_add_u32 s41, s41, s40
  s_lshl_b32 s41, s41, 11
  s_add_u32 s48, s41, s39
  s_add_u32 s49, s48, 4096
  v_mov_b32 v16, 0xc0135761
  v_mov_b32 v18, 0xbdd2d3e8
  v_mov_b32 v28, 1.0
  v_mov_b32 v17, 0xc0135761
  v_mov_b32 v19, 0xbdd2d3e8
  v_mov_b32 v29, 1.0
  v_mfma_f32_16x16x32_bf16 v[128:131], v[80:83], v[112:115], v[128:131]
  v_mfma_f32_16x16x32_bf16 v[132:135], v[84:87], v[112:115], v[132:135]
  v_mfma_f32_16x16x32_bf16 v[136:139], v[88:91], v[112:115], v[136:139]
  v_mfma_f32_16x16x32_bf16 v[140:143], v[92:95], v[112:115], v[140:143]
  v_mfma_f32_16x16x32_bf16 v[144:147], v[96:99], v[112:115], v[144:147]
  v_mfma_f32_16x16x32_bf16 v[148:151], v[100:103], v[112:115], v[148:151]
  v_mfma_f32_16x16x32_bf16 v[152:155], v[104:107], v[112:115], v[152:155]
  v_mfma_f32_16x16x32_bf16 v[156:159], v[108:111], v[112:115], v[156:159]
  v_mfma_f32_16x16x32_bf16 v[160:163], v[80:83], v[116:119], v[160:163]
  v_mfma_f32_16x16x32_bf16 v[164:167], v[84:87], v[116:119], v[164:167]
  s_nop 5
  v_pk_mul_f32 v[32:33], v[128:129], v[128:129]
  v_pk_mul_f32 v[34:35], v[130:131], v[130:131]
  v_pk_mul_f32 v[36:37], v[132:133], v[132:133]
  v_pk_mul_f32 v[38:39], v[134:135], v[134:135]
  v_pk_fma_f32 v[32:33], v[32:33], v[18:19], v[16:17]
  v_pk_fma_f32 v[34:35], v[34:35], v[18:19], v[16:17]
  v_pk_fma_f32 v[36:37], v[36:37], v[18:19], v[16:17]
  v_pk_fma_f32 v[38:39], v[38:39], v[18:19], v[16:17]
  v_pk_mul_f32 v[32:33], v[32:33], v[128:129]
  v_pk_mul_f32 v[34:35], v[34:35], v[130:131]
  v_pk_mul_f32 v[36:37], v[36:37], v[132:133]
  v_pk_mul_f32 v[38:39], v[38:39], v[134:135]
  v_exp_f32 v32, v32
  v_mfma_f32_16x16x32_bf16 v[168:171], v[88:91], v[116:119], v[168:171]
  v_exp_f32 v33, v33
  v_exp_f32 v34, v34
  v_exp_f32 v35, v35
  v_exp_f32 v36, v36
  v_exp_f32 v37, v37
  v_exp_f32 v38, v38
  v_exp_f32 v39, v39
  v_pk_mul_f32 v[144:145], v[128:129], v[144:145]
  v_pk_mul_f32 v[146:147], v[130:131], v[146:147]
  v_pk_mul_f32 v[148:149], v[132:133], v[148:149]
  v_pk_mul_f32 v[150:151], v[134:135], v[150:151]
  v_pk_add_f32 v[32:33], v[32:33], v[28:29]
  v_pk_add_f32 v[34:35], v[34:35], v[28:29]
  v_mfma_f32_16x16x32_bf16 v[172:175], v[92:95], v[116:119], v[172:175]
  v_pk_add_f32 v[36:37], v[36:37], v[28:29]
  v_pk_add_f32 v[38:39], v[38:39], v[28:29]
  v_rcp_f32 v32, v32
  v_rcp_f32 v33, v33
  v_rcp_f32 v34, v34
  v_rcp_f32 v35, v35
  v_rcp_f32 v36, v36
  v_rcp_f32 v37, v37
  v_rcp_f32 v38, v38
  v_rcp_f32 v39, v39
  s_nop 0
  v_pk_mul_f32 v[144:145], v[144:145], v[32:33]
  v_pk_mul_f32 v[146:147], v[146:147], v[34:35]
  v_mfma_f32_16x16x32_bf16 v[176:179], v[96:99], v[116:119], v[176:179]
  v_pk_mul_f32 v[148:149], v[148:149], v[36:37]
  v_pk_mul_f32 v[150:151], v[150:151], v[38:39]
  v_cvt_pk_bf16_f32 v64, v144, v145
  v_cvt_pk_bf16_f32 v65, v146, v147
  v_cvt_pk_bf16_f32 v66, v148, v149
  v_cvt_pk_bf16_f32 v67, v150, v151
  buffer_store_dwordx4 v[64:67], v3, s[20:23], s48 offen offset:0 sc1
  v_pk_mul_f32 v[40:41], v[136:137], v[136:137]
  v_pk_mul_f32 v[42:43], v[138:139], v[138:139]
  v_pk_mul_f32 v[44:45], v[140:141], v[140:141]
  v_pk_mul_f32 v[46:47], v[142:143], v[142:143]
  v_pk_fma_f32 v[40:41], v[40:41], v[18:19], v[16:17]
  v_pk_fma_f32 v[42:43], v[42:43], v[18:19], v[16:17]
  v_mfma_f32_16x16x32_bf16 v[180:183], v[100:103], v[116:119], v[180:183]
  v_pk_fma_f32 v[44:45], v[44:45], v[18:19], v[16:17]
  v_pk_fma_f32 v[46:47], v[46:47], v[18:19], v[16:17]
  v_pk_mul_f32 v[40:41], v[40:41], v[136:137]
  v_pk_mul_f32 v[42:43], v[42:43], v[138:139]
  v_pk_mul_f32 v[44:45], v[44:45], v[140:141]
  v_pk_mul_f32 v[46:47], v[46:47], v[142:143]
  v_exp_f32 v40, v40
  v_exp_f32 v41, v41
  v_exp_f32 v42, v42
  v_exp_f32 v43, v43
  v_exp_f32 v44, v44
  v_exp_f32 v45, v45
  v_exp_f32 v46, v46
  v_mfma_f32_16x16x32_bf16 v[184:187], v[104:107], v[116:119], v[184:187]
  v_exp_f32 v47, v47
  v_pk_mul_f32 v[152:153], v[136:137], v[152:153]
  v_pk_mul_f32 v[154:155], v[138:139], v[154:155]
  v_pk_mul_f32 v[156:157], v[140:141], v[156:157]
  v_pk_mul_f32 v[158:159], v[142:143], v[158:159]
  v_pk_add_f32 v[40:41], v[40:41], v[28:29]
  v_pk_add_f32 v[42:43], v[42:43], v[28:29]
  v_pk_add_f32 v[44:45], v[44:45], v[28:29]
  v_pk_add_f32 v[46:47], v[46:47], v[28:29]
  v_rcp_f32 v40, v40
  v_rcp_f32 v41, v41
  v_rcp_f32 v42, v42
  v_rcp_f32 v43, v43
  v_mfma_f32_16x16x32_bf16 v[188:191], v[108:111], v[116:119], v[188:191]
  v_rcp_f32 v44, v44
  v_rcp_f32 v45, v45
  v_rcp_f32 v46, v46
  v_rcp_f32 v47, v47
  s_nop 0
  v_pk_mul_f32 v[152:153], v[152:153], v[40:41]
  v_pk_mul_f32 v[154:155], v[154:155], v[42:43]
  v_pk_mul_f32 v[156:157], v[156:157], v[44:45]
  v_pk_mul_f32 v[158:159], v[158:159], v[46:47]
  v_cvt_pk_bf16_f32 v68, v152, v153
  v_cvt_pk_bf16_f32 v69, v154, v155
  v_cvt_pk_bf16_f32 v70, v156, v157
  v_cvt_pk_bf16_f32 v71, v158, v159
  buffer_store_dwordx4 v[68:71], v3, s[20:23], s49 offen offset:0 sc1
  v_mfma_f32_16x16x32_bf16 v[192:195], v[80:83], v[120:123], v[192:195]
  v_mfma_f32_16x16x32_bf16 v[196:199], v[84:87], v[120:123], v[196:199]
  s_nop 5
  v_pk_mul_f32 v[48:49], v[160:161], v[160:161]
  v_pk_mul_f32 v[50:51], v[162:163], v[162:163]
  v_pk_mul_f32 v[52:53], v[164:165], v[164:165]
  v_pk_mul_f32 v[54:55], v[166:167], v[166:167]
  v_pk_fma_f32 v[48:49], v[48:49], v[18:19], v[16:17]
  v_pk_fma_f32 v[50:51], v[50:51], v[18:19], v[16:17]
  v_pk_fma_f32 v[52:53], v[52:53], v[18:19], v[16:17]
  v_pk_fma_f32 v[54:55], v[54:55], v[18:19], v[16:17]
  v_pk_mul_f32 v[48:49], v[48:49], v[160:161]
  v_pk_mul_f32 v[50:51], v[50:51], v[162:163]
  v_pk_mul_f32 v[52:53], v[52:53], v[164:165]
  v_pk_mul_f32 v[54:55], v[54:55], v[166:167]
  v_exp_f32 v48, v48
  v_mfma_f32_16x16x32_bf16 v[200:203], v[88:91], v[120:123], v[200:203]
  v_exp_f32 v49, v49
  v_exp_f32 v50, v50
  v_exp_f32 v51, v51
  v_exp_f32 v52, v52
  v_exp_f32 v53, v53
  v_exp_f32 v54, v54
  v_exp_f32 v55, v55
  v_pk_mul_f32 v[176:177], v[160:161], v[176:177]
  v_pk_mul_f32 v[178:179], v[162:163], v[178:179]
  v_pk_mul_f32 v[180:181], v[164:165], v[180:181]
  v_pk_mul_f32 v[182:183], v[166:167], v[182:183]
  v_pk_add_f32 v[48:49], v[48:49], v[28:29]
  v_pk_add_f32 v[50:51], v[50:51], v[28:29]
  v_mfma_f32_16x16x32_bf16 v[204:207], v[92:95], v[120:123], v[204:207]
  v_pk_add_f32 v[52:53], v[52:53], v[28:29]
  v_pk_add_f32 v[54:55], v[54:55], v[28:29]
  v_rcp_f32 v48, v48
  v_rcp_f32 v49, v49
  v_rcp_f32 v50, v50
  v_rcp_f32 v51, v51
  v_rcp_f32 v52, v52
  v_rcp_f32 v53, v53
  v_rcp_f32 v54, v54
  v_rcp_f32 v55, v55
  s_nop 0
  v_pk_mul_f32 v[176:177], v[176:177], v[48:49]
  v_pk_mul_f32 v[178:179], v[178:179], v[50:51]
  v_mfma_f32_16x16x32_bf16 v[208:211], v[96:99], v[120:123], v[208:211]
  v_pk_mul_f32 v[180:181], v[180:181], v[52:53]
  v_pk_mul_f32 v[182:183], v[182:183], v[54:55]
  v_cvt_pk_bf16_f32 v72, v176, v177
  v_cvt_pk_bf16_f32 v73, v178, v179
  v_cvt_pk_bf16_f32 v74, v180, v181
  v_cvt_pk_bf16_f32 v75, v182, v183
  buffer_store_dwordx4 v[72:75], v3, s[20:23], s48 offen offset:1024 sc1
  v_pk_mul_f32 v[56:57], v[168:169], v[168:169]
  v_pk_mul_f32 v[58:59], v[170:171], v[170:171]
  v_pk_mul_f32 v[60:61], v[172:173], v[172:173]
  v_pk_mul_f32 v[62:63], v[174:175], v[174:175]
  v_pk_fma_f32 v[56:57], v[56:57], v[18:19], v[16:17]
  v_pk_fma_f32 v[58:59], v[58:59], v[18:19], v[16:17]
  v_mfma_f32_16x16x32_bf16 v[212:215], v[100:103], v[120:123], v[212:215]
  v_pk_fma_f32 v[60:61], v[60:61], v[18:19], v[16:17]
  v_pk_fma_f32 v[62:63], v[62:63], v[18:19], v[16:17]
  v_pk_mul_f32 v[56:57], v[56:57], v[168:169]
  v_pk_mul_f32 v[58:59], v[58:59], v[170:171]
  v_pk_mul_f32 v[60:61], v[60:61], v[172:173]
  v_pk_mul_f32 v[62:63], v[62:63], v[174:175]
  v_exp_f32 v56, v56
  v_exp_f32 v57, v57
  v_exp_f32 v58, v58
  v_exp_f32 v59, v59
  v_exp_f32 v60, v60
  v_exp_f32 v61, v61
  v_exp_f32 v62, v62
  v_mfma_f32_16x16x32_bf16 v[216:219], v[104:107], v[120:123], v[216:219]
  v_exp_f32 v63, v63
  v_pk_mul_f32 v[184:185], v[168:169], v[184:185]
  v_pk_mul_f32 v[186:187], v[170:171], v[186:187]
  v_pk_mul_f32 v[188:189], v[172:173], v[188:189]
  v_pk_mul_f32 v[190:191], v[174:175], v[190:191]
  v_pk_add_f32 v[56:57], v[56:57], v[28:29]
  v_pk_add_f32 v[58:59], v[58:59], v[28:29]
  v_pk_add_f32 v[60:61], v[60:61], v[28:29]
  v_pk_add_f32 v[62:63], v[62:63], v[28:29]
  v_rcp_f32 v56, v56
  v_rcp_f32 v57, v57
  v_rcp_f32 v58, v58
  v_rcp_f32 v59, v59
  v_mfma_f32_16x16x32_bf16 v[220:223], v[108:111], v[120:123], v[220:223]
  v_rcp_f32 v60, v60
  v_rcp_f32 v61, v61
  v_rcp_f32 v62, v62
  v_rcp_f32 v63, v63
  s_nop 0
  v_pk_mul_f32 v[184:185], v[184:185], v[56:57]
  v_pk_mul_f32 v[186:187], v[186:187], v[58:59]
  v_pk_mul_f32 v[188:189], v[188:189], v[60:61]
  v_pk_mul_f32 v[190:191], v[190:191], v[62:63]
  v_cvt_pk_bf16_f32 v76, v184, v185
  v_cvt_pk_bf16_f32 v77, v186, v187
  v_cvt_pk_bf16_f32 v78, v188, v189
  v_cvt_pk_bf16_f32 v79, v190, v191
  buffer_store_dwordx4 v[76:79], v3, s[20:23], s49 offen offset:1024 sc1
  v_mfma_f32_16x16x32_bf16 v[224:227], v[80:83], v[124:127], v[224:227]
  v_mfma_f32_16x16x32_bf16 v[228:231], v[84:87], v[124:127], v[228:231]
  s_nop 5
  v_pk_mul_f32 v[32:33], v[192:193], v[192:193]
  v_pk_mul_f32 v[34:35], v[194:195], v[194:195]
  v_pk_mul_f32 v[36:37], v[196:197], v[196:197]
  v_pk_mul_f32 v[38:39], v[198:199], v[198:199]
  v_pk_fma_f32 v[32:33], v[32:33], v[18:19], v[16:17]
  v_pk_fma_f32 v[34:35], v[34:35], v[18:19], v[16:17]
  v_pk_fma_f32 v[36:37], v[36:37], v[18:19], v[16:17]
  v_pk_fma_f32 v[38:39], v[38:39], v[18:19], v[16:17]
  v_pk_mul_f32 v[32:33], v[32:33], v[192:193]
  v_pk_mul_f32 v[34:35], v[34:35], v[194:195]
  v_pk_mul_f32 v[36:37], v[36:37], v[196:197]
  v_pk_mul_f32 v[38:39], v[38:39], v[198:199]
  v_exp_f32 v32, v32
  v_mfma_f32_16x16x32_bf16 v[232:235], v[88:91], v[124:127], v[232:235]
  v_exp_f32 v33, v33
  v_exp_f32 v34, v34
  v_exp_f32 v35, v35
  v_exp_f32 v36, v36
  v_exp_f32 v37, v37
  v_exp_f32 v38, v38
  v_exp_f32 v39, v39
  v_pk_mul_f32 v[208:209], v[192:193], v[208:209]
  v_pk_mul_f32 v[210:211], v[194:195], v[210:211]
  v_pk_mul_f32 v[212:213], v[196:197], v[212:213]
  v_pk_mul_f32 v[214:215], v[198:199], v[214:215]
  v_pk_add_f32 v[32:33], v[32:33], v[28:29]
  v_pk_add_f32 v[34:35], v[34:35], v[28:29]
  v_mfma_f32_16x16x32_bf16 v[236:239], v[92:95], v[124:127], v[236:239]
  v_pk_add_f32 v[36:37], v[36:37], v[28:29]
  v_pk_add_f32 v[38:39], v[38:39], v[28:29]
  v_rcp_f32 v32, v32
  v_rcp_f32 v33, v33
  v_rcp_f32 v34, v34
  v_rcp_f32 v35, v35
  v_rcp_f32 v36, v36
  v_rcp_f32 v37, v37
  v_rcp_f32 v38, v38
  v_rcp_f32 v39, v39
  s_nop 0
  v_pk_mul_f32 v[208:209], v[208:209], v[32:33]
  v_pk_mul_f32 v[210:211], v[210:211], v[34:35]
  v_mfma_f32_16x16x32_bf16 v[240:243], v[96:99], v[124:127], v[240:243]
  v_pk_mul_f32 v[212:213], v[212:213], v[36:37]
  v_pk_mul_f32 v[214:215], v[214:215], v[38:39]
  v_cvt_pk_bf16_f32 v64, v208, v209
  v_cvt_pk_bf16_f32 v65, v210, v211
  v_cvt_pk_bf16_f32 v66, v212, v213
  v_cvt_pk_bf16_f32 v67, v214, v215
  buffer_store_dwordx4 v[64:67], v3, s[20:23], s48 offen offset:2048 sc1
  v_pk_mul_f32 v[40:41], v[200:201], v[200:201]
  v_pk_mul_f32 v[42:43], v[202:203], v[202:203]
  v_pk_mul_f32 v[44:45], v[204:205], v[204:205]
  v_pk_mul_f32 v[46:47], v[206:207], v[206:207]
  v_pk_fma_f32 v[40:41], v[40:41], v[18:19], v[16:17]
  v_pk_fma_f32 v[42:43], v[42:43], v[18:19], v[16:17]
  v_mfma_f32_16x16x32_bf16 v[244:247], v[100:103], v[124:127], v[244:247]
  v_pk_fma_f32 v[44:45], v[44:45], v[18:19], v[16:17]
  v_pk_fma_f32 v[46:47], v[46:47], v[18:19], v[16:17]
  v_pk_mul_f32 v[40:41], v[40:41], v[200:201]
  v_pk_mul_f32 v[42:43], v[42:43], v[202:203]
  v_pk_mul_f32 v[44:45], v[44:45], v[204:205]
  v_pk_mul_f32 v[46:47], v[46:47], v[206:207]
  v_exp_f32 v40, v40
  v_exp_f32 v41, v41
  v_exp_f32 v42, v42
  v_exp_f32 v43, v43
  v_exp_f32 v44, v44
  v_exp_f32 v45, v45
  v_exp_f32 v46, v46
  v_mfma_f32_16x16x32_bf16 v[248:251], v[104:107], v[124:127], v[248:251]
  v_exp_f32 v47, v47
  v_pk_mul_f32 v[216:217], v[200:201], v[216:217]
  v_pk_mul_f32 v[218:219], v[202:203], v[218:219]
  v_pk_mul_f32 v[220:221], v[204:205], v[220:221]
  v_pk_mul_f32 v[222:223], v[206:207], v[222:223]
  v_pk_add_f32 v[40:41], v[40:41], v[28:29]
  v_pk_add_f32 v[42:43], v[42:43], v[28:29]
  v_pk_add_f32 v[44:45], v[44:45], v[28:29]
  v_pk_add_f32 v[46:47], v[46:47], v[28:29]
  v_rcp_f32 v40, v40
  v_rcp_f32 v41, v41
  v_rcp_f32 v42, v42
  v_rcp_f32 v43, v43
  v_mfma_f32_16x16x32_bf16 v[252:255], v[108:111], v[124:127], v[252:255]
  v_rcp_f32 v44, v44
  v_rcp_f32 v45, v45
  v_rcp_f32 v46, v46
  v_rcp_f32 v47, v47
  s_nop 0
  v_pk_mul_f32 v[216:217], v[216:217], v[40:41]
  v_pk_mul_f32 v[218:219], v[218:219], v[42:43]
  v_pk_mul_f32 v[220:221], v[220:221], v[44:45]
  v_pk_mul_f32 v[222:223], v[222:223], v[46:47]
  v_cvt_pk_bf16_f32 v68, v216, v217
  v_cvt_pk_bf16_f32 v69, v218, v219
  v_cvt_pk_bf16_f32 v70, v220, v221
  v_cvt_pk_bf16_f32 v71, v222, v223
  buffer_store_dwordx4 v[68:71], v3, s[20:23], s49 offen offset:2048 sc1
  s_nop 7
  v_pk_mul_f32 v[48:49], v[224:225], v[224:225]
  v_pk_mul_f32 v[50:51], v[226:227], v[226:227]
  v_pk_mul_f32 v[52:53], v[228:229], v[228:229]
  v_pk_mul_f32 v[54:55], v[230:231], v[230:231]
  v_pk_fma_f32 v[48:49], v[48:49], v[18:19], v[16:17]
  v_pk_fma_f32 v[50:51], v[50:51], v[18:19], v[16:17]
  v_pk_fma_f32 v[52:53], v[52:53], v[18:19], v[16:17]
  v_pk_fma_f32 v[54:55], v[54:55], v[18:19], v[16:17]
  v_pk_mul_f32 v[48:49], v[48:49], v[224:225]
  v_pk_mul_f32 v[50:51], v[50:51], v[226:227]
  v_pk_mul_f32 v[52:53], v[52:53], v[228:229]
  v_pk_mul_f32 v[54:55], v[54:55], v[230:231]
  v_exp_f32 v48, v48
  v_exp_f32 v49, v49
  v_exp_f32 v50, v50
  v_exp_f32 v51, v51
  v_exp_f32 v52, v52
  v_exp_f32 v53, v53
  v_exp_f32 v54, v54
  v_exp_f32 v55, v55
  v_pk_mul_f32 v[240:241], v[224:225], v[240:241]
  v_pk_mul_f32 v[242:243], v[226:227], v[242:243]
  v_pk_mul_f32 v[244:245], v[228:229], v[244:245]
  v_pk_mul_f32 v[246:247], v[230:231], v[246:247]
  v_pk_add_f32 v[48:49], v[48:49], v[28:29]
  v_pk_add_f32 v[50:51], v[50:51], v[28:29]
  v_pk_add_f32 v[52:53], v[52:53], v[28:29]
  v_pk_add_f32 v[54:55], v[54:55], v[28:29]
  v_rcp_f32 v48, v48
  v_rcp_f32 v49, v49
  v_rcp_f32 v50, v50
  v_rcp_f32 v51, v51
  v_rcp_f32 v52, v52
  v_rcp_f32 v53, v53
  v_rcp_f32 v54, v54
  v_rcp_f32 v55, v55
  s_nop 0
  v_pk_mul_f32 v[240:241], v[240:241], v[48:49]
  v_pk_mul_f32 v[242:243], v[242:243], v[50:51]
  v_pk_mul_f32 v[244:245], v[244:245], v[52:53]
  v_pk_mul_f32 v[246:247], v[246:247], v[54:55]
  v_cvt_pk_bf16_f32 v72, v240, v241
  v_cvt_pk_bf16_f32 v73, v242, v243
  v_cvt_pk_bf16_f32 v74, v244, v245
  v_cvt_pk_bf16_f32 v75, v246, v247
  buffer_store_dwordx4 v[72:75], v3, s[20:23], s48 offen offset:3072 sc1
  v_pk_mul_f32 v[56:57], v[232:233], v[232:233]
  v_pk_mul_f32 v[58:59], v[234:235], v[234:235]
  v_pk_mul_f32 v[60:61], v[236:237], v[236:237]
  v_pk_mul_f32 v[62:63], v[238:239], v[238:239]
  v_pk_fma_f32 v[56:57], v[56:57], v[18:19], v[16:17]
  v_pk_fma_f32 v[58:59], v[58:59], v[18:19], v[16:17]
  v_pk_fma_f32 v[60:61], v[60:61], v[18:19], v[16:17]
  v_pk_fma_f32 v[62:63], v[62:63], v[18:19], v[16:17]
  v_pk_mul_f32 v[56:57], v[56:57], v[232:233]
  v_pk_mul_f32 v[58:59], v[58:59], v[234:235]
  v_pk_mul_f32 v[60:61], v[60:61], v[236:237]
  v_pk_mul_f32 v[62:63], v[62:63], v[238:239]
  v_exp_f32 v56, v56
  v_exp_f32 v57, v57
  v_exp_f32 v58, v58
  v_exp_f32 v59, v59
  v_exp_f32 v60, v60
  v_exp_f32 v61, v61
  v_exp_f32 v62, v62
  v_exp_f32 v63, v63
  v_pk_mul_f32 v[248:249], v[232:233], v[248:249]
  v_pk_mul_f32 v[250:251], v[234:235], v[250:251]
  v_pk_mul_f32 v[252:253], v[236:237], v[252:253]
  v_pk_mul_f32 v[254:255], v[238:239], v[254:255]
  v_pk_add_f32 v[56:57], v[56:57], v[28:29]
  v_pk_add_f32 v[58:59], v[58:59], v[28:29]
  v_pk_add_f32 v[60:61], v[60:61], v[28:29]
  v_pk_add_f32 v[62:63], v[62:63], v[28:29]
  v_rcp_f32 v56, v56
  v_rcp_f32 v57, v57
  v_rcp_f32 v58, v58
  v_rcp_f32 v59, v59
  v_rcp_f32 v60, v60
  v_rcp_f32 v61, v61
  v_rcp_f32 v62, v62
  v_rcp_f32 v63, v63
  s_nop 0
  v_pk_mul_f32 v[248:249], v[248:249], v[56:57]
  v_pk_mul_f32 v[250:251], v[250:251], v[58:59]
  v_pk_mul_f32 v[252:253], v[252:253], v[60:61]
  v_pk_mul_f32 v[254:255], v[254:255], v[62:63]
  v_cvt_pk_bf16_f32 v76, v248, v249
  v_cvt_pk_bf16_f32 v77, v250, v251
  v_cvt_pk_bf16_f32 v78, v252, v253
  v_cvt_pk_bf16_f32 v79, v254, v255
  buffer_store_dwordx4 v[76:79], v3, s[20:23], s49 offen offset:3072 sc1
  s_branch g3_p2
g3_typeB:
  ds_read_b128 v[64:67], v10 offset:0
  ds_read_b64_tr_b16 v[32:33], v4 offset:0
  ds_read_b64_tr_b16 v[34:35], v4 offset:512
  ds_read_b64_tr_b16 v[36:37], v4 offset:32
  ds_read_b64_tr_b16 v[38:39], v4 offset:544
  ds_read_b128 v[68:71], v10 offset:1024
  ds_read_b64_tr_b16 v[40:41], v20 offset:0
  ds_read_b64_tr_b16 v[42:43], v20 offset:512
  ds_read_b64_tr_b16 v[44:45], v4 offset:1024
  ds_read_b64_tr_b16 v[46:47], v4 offset:1536
  ds_read_b128 v[72:75], v10 offset:4128
  ds_read_b64_tr_b16 v[48:49], v4 offset:1056
  ds_read_b64_tr_b16 v[50:51], v4 offset:1568
  ds_read_b64_tr_b16 v[52:53], v20 offset:1024
  ds_read_b64_tr_b16 v[54:55], v20 offset:1536
  ds_read_b128 v[76:79], v10 offset:5152
  s_add_u32 m0, s26, 99072
  s_nop 0
  buffer_load_dwordx4 v1, s[8:11], s24 offen lds
  s_add_u32 m0, s26, 100096
  s_nop 0
  buffer_load_dwordx4 v1, s[12:15], s24 offen lds
  s_add_u32 m0, s26, 101120
  s_nop 0
  buffer_load_dwordx4 v2, s[16:19], s25 offen sc1 lds
  buffer_load_dwordx4 v2, s[16:19], s25 offen offset:1024 sc1 lds
  s_add_u32 s24, s24, 229376
  s_add_u32 s25, s25, 16384
  s_mov_b32 s27, 7
g3_loop1:
  s_waitcnt vmcnt(8) lgkmcnt(0)
  s_barrier
  v_mfma_f32_16x16x32_bf16 v[128:131], v[32:35], v[64:67], v[128:131]
  ds_read_b128 v[112:115], v11 offset:0
  ds_read_b64_tr_b16 v[80:81], v5 offset:0
  v_mfma_f32_16x16x32_bf16 v[132:135], v[36:39], v[64:67], v[132:135]
  ds_read_b64_tr_b16 v[82:83], v5 offset:512
  s_add_u32 m0, s26, 0
  v_mfma_f32_16x16x32_bf16 v[136:139], v[40:43], v[64:67], v[136:139]
  ds_read_b64_tr_b16 v[84:85], v5 offset:32
  buffer_load_dwordx4 v1, s[8:11], s24 offen lds
  v_mfma_f32_16x16x32_bf16 v[140:143], v[44:47], v[64:67], v[140:143]
  ds_read_b64_tr_b16 v[86:87], v5 offset:544
  v_mfma_f32_16x16x32_bf16 v[144:147], v[48:51], v[64:67], v[144:147]
  ds_read_b128 v[116:119], v11 offset:1024
  v_mfma_f32_16x16x32_bf16 v[148:151], v[52:55], v[64:67], v[148:151]
  ds_read_b64_tr_b16 v[88:89], v21 offset:0
  v_mfma_f32_16x16x32_bf16 v[152:155], v[32:35], v[68:71], v[152:155]
  ds_read_b64_tr_b16 v[90:91], v21 offset:512
  v_mfma_f32_16x16x32_bf16 v[156:159], v[36:39], v[68:71], v[156:159]
  ds_read_b64_tr_b16 v[92:93], v5 offset:1024
  s_add_u32 m0, s26, 1024
  v_mfma_f32_16x16x32_bf16 v[160:163], v[40:43], v[68:71], v[160:163]
  ds_read_b64_tr_b16 v[94:95], v5 offset:1536
  buffer_load_dwordx4 v1, s[12:15], s24 offen lds
  v_mfma_f32_16x16x32_bf16 v[164:167], v[44:47], v[68:71], v[164:167]
  ds_read_b128 v[120:123], v11 offset:4128
  ds_read_b64_tr_b16 v[96:97], v5 offset:1056
  v_mfma_f32_16x16x32_bf16 v[168:171], v[48:51], v[68:71], v[168:171]
  ds_read_b64_tr_b16 v[98:99], v5 offset:1568
  v_mfma_f32_16x16x32_bf16 v[172:175], v[52:55], v[68:71], v[172:175]
  ds_read_b64_tr_b16 v[100:101], v21 offset:1024
  v_mfma_f32_16x16x32_bf16 v[176:179], v[32:35], v[72:75], v[176:179]
  ds_read_b64_tr_b16 v[102:103], v21 offset:1536
  v_mfma_f32_16x16x32_bf16 v[180:183], v[36:39], v[72:75], v[180:183]
  ds_read_b128 v[124:127], v11 offset:5152
  s_add_u32 m0, s26, 2048
  v_mfma_f32_16x16x32_bf16 v[184:187], v[40:43], v[72:75], v[184:187]
  buffer_load_dwordx4 v2, s[16:19], s25 offen sc1 lds
  v_mfma_f32_16x16x32_bf16 v[188:191], v[44:47], v[72:75], v[188:191]
  v_mfma_f32_16x16x32_bf16 v[192:195], v[48:51], v[72:75], v[192:195]
  v_mfma_f32_16x16x32_bf16 v[196:199], v[52:55], v[72:75], v[196:199]
  v_mfma_f32_16x16x32_bf16 v[200:203], v[32:35], v[76:79], v[200:203]
  v_mfma_f32_16x16x32_bf16 v[204:207], v[36:39], v[76:79], v[204:207]
  v_mfma_f32_16x16x32_bf16 v[208:211], v[40:43], v[76:79], v[208:211]
  buffer_load_dwordx4 v2, s[16:19], s25 offen offset:1024 sc1 lds
  s_add_u32 s24, s24, 229376
  s_add_u32 s25, s25, 16384
  v_mfma_f32_16x16x32_bf16 v[212:215], v[44:47], v[76:79], v[212:215]
  v_mfma_f32_16x16x32_bf16 v[216:219], v[48:51], v[76:79], v[216:219]
  v_mfma_f32_16x16x32_bf16 v[220:223], v[52:55], v[76:79], v[220:223]
  s_waitcnt vmcnt(8) lgkmcnt(0)
  s_barrier
  v_mfma_f32_16x16x32_bf16 v[128:131], v[80:83], v[112:115], v[128:131]
  ds_read_b128 v[64:67], v12 offset:0
  ds_read_b64_tr_b16 v[32:33], v6 offset:0
  v_mfma_f32_16x16x32_bf16 v[132:135], v[84:87], v[112:115], v[132:135]
  ds_read_b64_tr_b16 v[34:35], v6 offset:512
  s_add_u32 m0, s26, 33024
  v_mfma_f32_16x16x32_bf16 v[136:139], v[88:91], v[112:115], v[136:139]
  ds_read_b64_tr_b16 v[36:37], v6 offset:32
  buffer_load_dwordx4 v1, s[8:11], s24 offen lds
  v_mfma_f32_16x16x32_bf16 v[140:143], v[92:95], v[112:115], v[140:143]
  ds_read_b64_tr_b16 v[38:39], v6 offset:544
  v_mfma_f32_16x16x32_bf16 v[144:147], v[96:99], v[112:115], v[144:147]
  ds_read_b128 v[68:71], v12 offset:1024
  v_mfma_f32_16x16x32_bf16 v[148:151], v[100:103], v[112:115], v[148:151]
  ds_read_b64_tr_b16 v[40:41], v22 offset:0
  v_mfma_f32_16x16x32_bf16 v[152:155], v[80:83], v[116:119], v[152:155]
  ds_read_b64_tr_b16 v[42:43], v22 offset:512
  v_mfma_f32_16x16x32_bf16 v[156:159], v[84:87], v[116:119], v[156:159]
  ds_read_b64_tr_b16 v[44:45], v6 offset:1024
  s_add_u32 m0, s26, 34048
  v_mfma_f32_16x16x32_bf16 v[160:163], v[88:91], v[116:119], v[160:163]
  ds_read_b64_tr_b16 v[46:47], v6 offset:1536
  buffer_load_dwordx4 v1, s[12:15], s24 offen lds
  v_mfma_f32_16x16x32_bf16 v[164:167], v[92:95], v[116:119], v[164:167]
  ds_read_b128 v[72:75], v12 offset:4128
  ds_read_b64_tr_b16 v[48:49], v6 offset:1056
  v_mfma_f32_16x16x32_bf16 v[168:171], v[96:99], v[116:119], v[168:171]
  ds_read_b64_tr_b16 v[50:51], v6 offset:1568
  v_mfma_f32_16x16x32_bf16 v[172:175], v[100:103], v[116:119], v[172:175]
  ds_read_b64_tr_b16 v[52:53], v22 offset:1024
  v_mfma_f32_16x16x32_bf16 v[176:179], v[80:83], v[120:123], v[176:179]
  ds_read_b64_tr_b16 v[54:55], v22 offset:1536
  v_mfma_f32_16x16x32_bf16 v[180:183], v[84:87], v[120:123], v[180:183]
  ds_read_b128 v[76:79], v12 offset:5152
  s_add_u32 m0, s26, 35072
  v_mfma_f32_16x16x32_bf16 v[184:187], v[88:91], v[120:123], v[184:187]
  buffer_load_dwordx4 v2, s[16:19], s25 offen sc1 lds
  v_mfma_f32_16x16x32_bf16 v[188:191], v[92:95], v[120:123], v[188:191]
  v_mfma_f32_16x16x32_bf16 v[192:195], v[96:99], v[120:123], v[192:195]
  v_mfma_f32_16x16x32_bf16 v[196:199], v[100:103], v[120:123], v[196:199]
  v_mfma_f32_16x16x32_bf16 v[200:203], v[80:83], v[124:127], v[200:203]
  v_mfma_f32_16x16x32_bf16 v[204:207], v[84:87], v[124:127], v[204:207]
  v_mfma_f32_16x16x32_bf16 v[208:211], v[88:91], v[124:127], v[208:211]
  buffer_load_dwordx4 v2, s[16:19], s25 offen offset:1024 sc1 lds
  s_add_u32 s24, s24, 229376
  s_add_u32 s25, s25, 16384
  v_mfma_f32_16x16x32_bf16 v[212:215], v[92:95], v[124:127], v[212:215]
  v_mfma_f32_16x16x32_bf16 v[216:219], v[96:99], v[124:127], v[216:219]
  v_mfma_f32_16x16x32_bf16 v[220:223], v[100:103], v[124:127], v[220:223]
  s_waitcnt vmcnt(8) lgkmcnt(0)
  s_barrier
  v_mfma_f32_16x16x32_bf16 v[128:131], v[32:35], v[64:67], v[128:131]
  ds_read_b128 v[112:115], v13 offset:0
  ds_read_b64_tr_b16 v[80:81], v7 offset:0
  v_mfma_f32_16x16x32_bf16 v[132:135], v[36:39], v[64:67], v[132:135]
  ds_read_b64_tr_b16 v[82:83], v7 offset:512
  s_add_u32 m0, s26, 66048
  v_mfma_f32_16x16x32_bf16 v[136:139], v[40:43], v[64:67], v[136:139]
  ds_read_b64_tr_b16 v[84:85], v7 offset:32
  buffer_load_dwordx4 v1, s[8:11], s24 offen lds
  v_mfma_f32_16x16x32_bf16 v[140:143], v[44:47], v[64:67], v[140:143]
  ds_read_b64_tr_b16 v[86:87], v7 offset:544
  v_mfma_f32_16x16x32_bf16 v[144:147], v[48:51], v[64:67], v[144:147]
  ds_read_b128 v[116:119], v13 offset:1024
  v_mfma_f32_16x16x32_bf16 v[148:151], v[52:55], v[64:67], v[148:151]
  ds_read_b64_tr_b16 v[88:89], v23 offset:0
  v_mfma_f32_16x16x32_bf16 v[152:155], v[32:35], v[68:71], v[152:155]
  ds_read_b64_tr_b16 v[90:91], v23 offset:512
  v_mfma_f32_16x16x32_bf16 v[156:159], v[36:39], v[68:71], v[156:159]
  ds_read_b64_tr_b16 v[92:93], v7 offset:1024
  s_add_u32 m0, s26, 67072
  v_mfma_f32_16x16x32_bf16 v[160:163], v[40:43], v[68:71], v[160:163]
  ds_read_b64_tr_b16 v[94:95], v7 offset:1536
  buffer_load_dwordx4 v1, s[12:15], s24 offen lds
  v_mfma_f32_16x16x32_bf16 v[164:167], v[44:47], v[68:71], v[164:167]
  ds_read_b128 v[120:123], v13 offset:4128
  ds_read_b64_tr_b16 v[96:97], v7 offset:1056
  v_mfma_f32_16x16x32_bf16 v[168:171], v[48:51], v[68:71], v[168:171]
  ds_read_b64_tr_b16 v[98:99], v7 offset:1568
  v_mfma_f32_16x16x32_bf16 v[172:175], v[52:55], v[68:71], v[172:175]
  ds_read_b64_tr_b16 v[100:101], v23 offset:1024
  v_mfma_f32_16x16x32_bf16 v[176:179], v[32:35], v[72:75], v[176:179]
  ds_read_b64_tr_b16 v[102:103], v23 offset:1536
  v_mfma_f32_16x16x32_bf16 v[180:183], v[36:39], v[72:75], v[180:183]
  ds_read_b128 v[124:127], v13 offset:5152
  s_add_u32 m0, s26, 68096
  v_mfma_f32_16x16x32_bf16 v[184:187], v[40:43], v[72:75], v[184:187]
  buffer_load_dwordx4 v2, s[16:19], s25 offen sc1 lds
  v_mfma_f32_16x16x32_bf16 v[188:191], v[44:47], v[72:75], v[188:191]
  v_mfma_f32_16x16x32_bf16 v[192:195], v[48:51], v[72:75], v[192:195]
  v_mfma_f32_16x16x32_bf16 v[196:199], v[52:55], v[72:75], v[196:199]
  v_mfma_f32_16x16x32_bf16 v[200:203], v[32:35], v[76:79], v[200:203]
  v_mfma_f32_16x16x32_bf16 v[204:207], v[36:39], v[76:79], v[204:207]
  v_mfma_f32_16x16x32_bf16 v[208:211], v[40:43], v[76:79], v[208:211]
  buffer_load_dwordx4 v2, s[16:19], s25 offen offset:1024 sc1 lds
  s_add_u32 s24, s24, 229376
  s_add_u32 s25, s25, 16384
  v_mfma_f32_16x16x32_bf16 v[212:215], v[44:47], v[76:79], v[212:215]
  v_mfma_f32_16x16x32_bf16 v[216:219], v[48:51], v[76:79], v[216:219]
  v_mfma_f32_16x16x32_bf16 v[220:223], v[52:55], v[76:79], v[220:223]
  s_waitcnt vmcnt(8) lgkmcnt(0)
  s_barrier
  v_mfma_f32_16x16x32_bf16 v[128:131], v[80:83], v[112:115], v[128:131]
  ds_read_b128 v[64:67], v10 offset:0
  ds_read_b64_tr_b16 v[32:33], v4 offset:0
  v_mfma_f32_16x16x32_bf16 v[132:135], v[84:87], v[112:115], v[132:135]
  ds_read_b64_tr_b16 v[34:35], v4 offset:512
  s_add_u32 m0, s26, 99072
  v_mfma_f32_16x16x32_bf16 v[136:139], v[88:91], v[112:115], v[136:139]
  ds_read_b64_tr_b16 v[36:37], v4 offset:32
  buffer_load_dwordx4 v1, s[8:11], s24 offen lds
  v_mfma_f32_16x16x32_bf16 v[140:143], v[92:95], v[112:115], v[140:143]
  ds_read_b64_tr_b16 v[38:39], v4 offset:544
  v_mfma_f32_16x16x32_bf16 v[144:147], v[96:99], v[112:115], v[144:147]
  ds_read_b128 v[68:71], v10 offset:1024
  v_mfma_f32_16x16x32_bf16 v[148:151], v[100:103], v[112:115], v[148:151]
  ds_read_b64_tr_b16 v[40:41], v20 offset:0
  v_mfma_f32_16x16x32_bf16 v[152:155], v[80:83], v[116:119], v[152:155]
  ds_read_b64_tr_b16 v[42:43], v20 offset:512
  v_mfma_f32_16x16x32_bf16 v[156:159], v[84:87], v[116:119], v[156:159]
  ds_read_b64_tr_b16 v[44:45], v4 offset:1024
  s_add_u32 m0, s26, 100096
  v_mfma_f32_16x16x32_bf16 v[160:163], v[88:91], v[116:119], v[160:163]
  ds_read_b64_tr_b16 v[46:47], v4 offset:1536
  buffer_load_dwordx4 v1, s[12:15], s24 offen lds
  v_mfma_f32_16x16x32_bf16 v[164:167], v[92:95], v[116:119], v[164:167]
  ds_read_b128 v[72:75], v10 offset:4128
  ds_read_b64_tr_b16 v[48:49], v4 offset:1056
  v_mfma_f32_16x16x32_bf16 v[168:171], v[96:99], v[116:119], v[168:171]
  ds_read_b64_tr_b16 v[50:51], v4 offset:1568
  v_mfma_f32_16x16x32_bf16 v[172:175], v[100:103], v[116:119], v[172:175]
  ds_read_b64_tr_b16 v[52:53], v20 offset:1024
  v_mfma_f32_16x16x32_bf16 v[176:179], v[80:83], v[120:123], v[176:179]
  ds_read_b64_tr_b16 v[54:55], v20 offset:1536
  v_mfma_f32_16x16x32_bf16 v[180:183], v[84:87], v[120:123], v[180:183]
  ds_read_b128 v[76:79], v10 offset:5152
  s_add_u32 m0, s26, 101120
  v_mfma_f32_16x16x32_bf16 v[184:187], v[88:91], v[120:123], v[184:187]
  buffer_load_dwordx4 v2, s[16:19], s25 offen sc1 lds
  v_mfma_f32_16x16x32_bf16 v[188:191], v[92:95], v[120:123], v[188:191]
  v_mfma_f32_16x16x32_bf16 v[192:195], v[96:99], v[120:123], v[192:195]
  v_mfma_f32_16x16x32_bf16 v[196:199], v[100:103], v[120:123], v[196:199]
  v_mfma_f32_16x16x32_bf16 v[200:203], v[80:83], v[124:127], v[200:203]
  v_mfma_f32_16x16x32_bf16 v[204:207], v[84:87], v[124:127], v[204:207]
  v_mfma_f32_16x16x32_bf16 v[208:211], v[88:91], v[124:127], v[208:211]
  buffer_load_dwordx4 v2, s[16:19], s25 offen offset:1024 sc1 lds
  s_add_u32 s24, s24, 229376
  s_add_u32 s25, s25, 16384
  v_mfma_f32_16x16x32_bf16 v[212:215], v[92:95], v[124:127], v[212:215]
  v_mfma_f32_16x16x32_bf16 v[216:219], v[96:99], v[124:127], v[216:219]
  v_mfma_f32_16x16x32_bf16 v[220:223], v[100:103], v[124:127], v[220:223]
  s_sub_u32 s27, s27, 1
  s_cmp_lg_u32 s27, 0
  s_cbranch_scc1 g3_loop1
  s_waitcnt vmcnt(8) lgkmcnt(0)
  s_barrier
  v_mfma_f32_16x16x32_bf16 v[128:131], v[32:35], v[64:67], v[128:131]
  ds_read_b128 v[112:115], v11 offset:0
  ds_read_b64_tr_b16 v[80:81], v5 offset:0
  v_mfma_f32_16x16x32_bf16 v[132:135], v[36:39], v[64:67], v[132:135]
  ds_read_b64_tr_b16 v[82:83], v5 offset:512
  v_mfma_f32_16x16x32_bf16 v[136:139], v[40:43], v[64:67], v[136:139]
  ds_read_b64_tr_b16 v[84:85], v5 offset:32
  v_mfma_f32_16x16x32_bf16 v[140:143], v[44:47], v[64:67], v[140:143]
  ds_read_b64_tr_b16 v[86:87], v5 offset:544
  v_mfma_f32_16x16x32_bf16 v[144:147], v[48:51], v[64:67], v[144:147]
  ds_read_b128 v[116:119], v11 offset:1024
  v_mfma_f32_16x16x32_bf16 v[148:151], v[52:55], v[64:67], v[148:151]
  ds_read_b64_tr_b16 v[88:89], v21 offset:0
  v_mfma_f32_16x16x32_bf16 v[152:155], v[32:35], v[68:71], v[152:155]
  ds_read_b64_tr_b16 v[90:91], v21 offset:512
  v_mfma_f32_16x16x32_bf16 v[156:159], v[36:39], v[68:71], v[156:159]
  ds_read_b64_tr_b16 v[92:93], v5 offset:1024
  v_mfma_f32_16x16x32_bf16 v[160:163], v[40:43], v[68:71], v[160:163]
  ds_read_b64_tr_b16 v[94:95], v5 offset:1536
  v_mfma_f32_16x16x32_bf16 v[164:167], v[44:47], v[68:71], v[164:167]
  ds_read_b128 v[120:123], v11 offset:4128
  ds_read_b64_tr_b16 v[96:97], v5 offset:1056
  v_mfma_f32_16x16x32_bf16 v[168:171], v[48:51], v[68:71], v[168:171]
  ds_read_b64_tr_b16 v[98:99], v5 offset:1568
  v_mfma_f32_16x16x32_bf16 v[172:175], v[52:55], v[68:71], v[172:175]
  ds_read_b64_tr_b16 v[100:101], v21 offset:1024
  v_mfma_f32_16x16x32_bf16 v[176:179], v[32:35], v[72:75], v[176:179]
  ds_read_b64_tr_b16 v[102:103], v21 offset:1536
  v_mfma_f32_16x16x32_bf16 v[180:183], v[36:39], v[72:75], v[180:183]
  ds_read_b128 v[124:127], v11 offset:5152
  v_mfma_f32_16x16x32_bf16 v[184:187], v[40:43], v[72:75], v[184:187]
  v_mfma_f32_16x16x32_bf16 v[188:191], v[44:47], v[72:75], v[188:191]
  v_mfma_f32_16x16x32_bf16 v[192:195], v[48:51], v[72:75], v[192:195]
  v_mfma_f32_16x16x32_bf16 v[196:199], v[52:55], v[72:75], v[196:199]
  v_mfma_f32_16x16x32_bf16 v[200:203], v[32:35], v[76:79], v[200:203]
  v_mfma_f32_16x16x32_bf16 v[204:207], v[36:39], v[76:79], v[204:207]
  v_mfma_f32_16x16x32_bf16 v[208:211], v[40:43], v[76:79], v[208:211]
  v_mfma_f32_16x16x32_bf16 v[212:215], v[44:47], v[76:79], v[212:215]
  v_mfma_f32_16x16x32_bf16 v[216:219], v[48:51], v[76:79], v[216:219]
  v_mfma_f32_16x16x32_bf16 v[220:223], v[52:55], v[76:79], v[220:223]
  s_waitcnt vmcnt(4) lgkmcnt(0)
  s_barrier
  v_mfma_f32_16x16x32_bf16 v[128:131], v[80:83], v[112:115], v[128:131]
  ds_read_b128 v[64:67], v12 offset:0
  ds_read_b64_tr_b16 v[32:33], v6 offset:0
  v_mfma_f32_16x16x32_bf16 v[132:135], v[84:87], v[112:115], v[132:135]
  ds_read_b64_tr_b16 v[34:35], v6 offset:512
  v_mfma_f32_16x16x32_bf16 v[136:139], v[88:91], v[112:115], v[136:139]
  ds_read_b64_tr_b16 v[36:37], v6 offset:32
  v_mfma_f32_16x16x32_bf16 v[140:143], v[92:95], v[112:115], v[140:143]
  ds_read_b64_tr_b16 v[38:39], v6 offset:544
  v_mfma_f32_16x16x32_bf16 v[144:147], v[96:99], v[112:115], v[144:147]
  ds_read_b128 v[68:71], v12 offset:1024
  v_mfma_f32_16x16x32_bf16 v[148:151], v[100:103], v[112:115], v[148:151]
  ds_read_b64_tr_b16 v[40:41], v22 offset:0
  v_mfma_f32_16x16x32_bf16 v[152:155], v[80:83], v[116:119], v[152:155]
  ds_read_b64_tr_b16 v[42:43], v22 offset:512
  v_mfma_f32_16x16x32_bf16 v[156:159], v[84:87], v[116:119], v[156:159]
  ds_read_b64_tr_b16 v[44:45], v6 offset:1024
  v_mfma_f32_16x16x32_bf16 v[160:163], v[88:91], v[116:119], v[160:163]
  ds_read_b64_tr_b16 v[46:47], v6 offset:1536
  v_mfma_f32_16x16x32_bf16 v[164:167], v[92:95], v[116:119], v[164:167]
  ds_read_b128 v[72:75], v12 offset:4128
  ds_read_b64_tr_b16 v[48:49], v6 offset:1056
  v_mfma_f32_16x16x32_bf16 v[168:171], v[96:99], v[116:119], v[168:171]
  ds_read_b64_tr_b16 v[50:51], v6 offset:1568
  v_mfma_f32_16x16x32_bf16 v[172:175], v[100:103], v[116:119], v[172:175]
  ds_read_b64_tr_b16 v[52:53], v22 offset:1024
  v_mfma_f32_16x16x32_bf16 v[176:179], v[80:83], v[120:123], v[176:179]
  ds_read_b64_tr_b16 v[54:55], v22 offset:1536
  v_mfma_f32_16x16x32_bf16 v[180:183], v[84:87], v[120:123], v[180:183]
  ds_read_b128 v[76:79], v12 offset:5152
  v_mfma_f32_16x16x32_bf16 v[184:187], v[88:91], v[120:123], v[184:187]
  v_mfma_f32_16x16x32_bf16 v[188:191], v[92:95], v[120:123], v[188:191]
  v_mfma_f32_16x16x32_bf16 v[192:195], v[96:99], v[120:123], v[192:195]
  v_mfma_f32_16x16x32_bf16 v[196:199], v[100:103], v[120:123], v[196:199]
  v_mfma_f32_16x16x32_bf16 v[200:203], v[80:83], v[124:127], v[200:203]
  v_mfma_f32_16x16x32_bf16 v[204:207], v[84:87], v[124:127], v[204:207]
  v_mfma_f32_16x16x32_bf16 v[208:211], v[88:91], v[124:127], v[208:211]
  v_mfma_f32_16x16x32_bf16 v[212:215], v[92:95], v[124:127], v[212:215]
  v_mfma_f32_16x16x32_bf16 v[216:219], v[96:99], v[124:127], v[216:219]
  v_mfma_f32_16x16x32_bf16 v[220:223], v[100:103], v[124:127], v[220:223]
  s_waitcnt vmcnt(0) lgkmcnt(0)
  s_barrier
  v_mfma_f32_16x16x32_bf16 v[128:131], v[32:35], v[64:67], v[128:131]
  ds_read_b128 v[112:115], v13 offset:0
  ds_read_b64_tr_b16 v[80:81], v7 offset:0
  v_mfma_f32_16x16x32_bf16 v[132:135], v[36:39], v[64:67], v[132:135]
  ds_read_b64_tr_b16 v[82:83], v7 offset:512
  v_mfma_f32_16x16x32_bf16 v[136:139], v[40:43], v[64:67], v[136:139]
  ds_read_b64_tr_b16 v[84:85], v7 offset:32
  v_mfma_f32_16x16x32_bf16 v[140:143], v[44:47], v[64:67], v[140:143]
  ds_read_b64_tr_b16 v[86:87], v7 offset:544
  v_mfma_f32_16x16x32_bf16 v[144:147], v[48:51], v[64:67], v[144:147]
  ds_read_b128 v[116:119], v13 offset:1024
  v_mfma_f32_16x16x32_bf16 v[148:151], v[52:55], v[64:67], v[148:151]
  ds_read_b64_tr_b16 v[88:89], v23 offset:0
  v_mfma_f32_16x16x32_bf16 v[152:155], v[32:35], v[68:71], v[152:155]
  ds_read_b64_tr_b16 v[90:91], v23 offset:512
  v_mfma_f32_16x16x32_bf16 v[156:159], v[36:39], v[68:71], v[156:159]
  ds_read_b64_tr_b16 v[92:93], v7 offset:1024
  v_mfma_f32_16x16x32_bf16 v[160:163], v[40:43], v[68:71], v[160:163]
  ds_read_b64_tr_b16 v[94:95], v7 offset:1536
  v_mfma_f32_16x16x32_bf16 v[164:167], v[44:47], v[68:71], v[164:167]
  ds_read_b128 v[120:123], v13 offset:4128
  ds_read_b64_tr_b16 v[96:97], v7 offset:1056
  v_mfma_f32_16x16x32_bf16 v[168:171], v[48:51], v[68:71], v[168:171]
  ds_read_b64_tr_b16 v[98:99], v7 offset:1568
  v_mfma_f32_16x16x32_bf16 v[172:175], v[52:55], v[68:71], v[172:175]
  ds_read_b64_tr_b16 v[100:101], v23 offset:1024
  v_mfma_f32_16x16x32_bf16 v[176:179], v[32:35], v[72:75], v[176:179]
  ds_read_b64_tr_b16 v[102:103], v23 offset:1536
  v_mfma_f32_16x16x32_bf16 v[180:183], v[36:39], v[72:75], v[180:183]
  ds_read_b128 v[124:127], v13 offset:5152
  v_mfma_f32_16x16x32_bf16 v[184:187], v[40:43], v[72:75], v[184:187]
  v_mfma_f32_16x16x32_bf16 v[188:191], v[44:47], v[72:75], v[188:191]
  v_mfma_f32_16x16x32_bf16 v[192:195], v[48:51], v[72:75], v[192:195]
  v_mfma_f32_16x16x32_bf16 v[196:199], v[52:55], v[72:75], v[196:199]
  v_mfma_f32_16x16x32_bf16 v[200:203], v[32:35], v[76:79], v[200:203]
  v_mfma_f32_16x16x32_bf16 v[204:207], v[36:39], v[76:79], v[204:207]
  v_mfma_f32_16x16x32_bf16 v[208:211], v[40:43], v[76:79], v[208:211]
  v_mfma_f32_16x16x32_bf16 v[212:215], v[44:47], v[76:79], v[212:215]
  v_mfma_f32_16x16x32_bf16 v[216:219], v[48:51], v[76:79], v[216:219]
  v_mfma_f32_16x16x32_bf16 v[220:223], v[52:55], v[76:79], v[220:223]
  s_waitcnt lgkmcnt(0)
  buffer_load_dword v31, v30, s[44:47], 0 offen
  s_and_b32 s39, s28, 3
  s_lshl_b32 s40, s36, 2
  s_add_u32 s39, s39, s40
  s_mul_i32 s39, s39, 458752
  s_mul_i32 s40, s37, 7
  s_and_b32 s41, s37, 1
  s_cmp_eq_u32 s41, 0
  s_cselect_b32 s41, 4, 1
  s_cselect_b32 s42, 6, 0
  s_add_u32 s41, s41, s40
  s_lshl_b32 s41, s41, 11
  s_add_u32 s48, s41, s39
  s_add_u32 s42, s42, s40
  s_lshr_b32 s41, s42, 1
  s_lshl_b32 s41, s41, 12
  s_and_b32 s42, s42, 1
  s_lshl_b32 s42, s42, 3
  s_add_u32 s41, s41, s42
  s_add_u32 s49, s41, s39
  v_mov_b32 v16, 0xc0135761
  v_mov_b32 v18, 0xbdd2d3e8
  v_mov_b32 v28, 1.0
  v_mov_b32 v17, 0xc0135761
  v_mov_b32 v19, 0xbdd2d3e8
  v_mov_b32 v29, 1.0
  v_mfma_f32_16x16x32_bf16 v[128:131], v[80:83], v[112:115], v[128:131]
  v_mfma_f32_16x16x32_bf16 v[132:135], v[84:87], v[112:115], v[132:135]
  v_mfma_f32_16x16x32_bf16 v[136:139], v[88:91], v[112:115], v[136:139]
  v_mfma_f32_16x16x32_bf16 v[140:143], v[92:95], v[112:115], v[140:143]
  v_mfma_f32_16x16x32_bf16 v[144:147], v[96:99], v[112:115], v[144:147]
  v_mfma_f32_16x16x32_bf16 v[148:151], v[100:103], v[112:115], v[148:151]
  v_mfma_f32_16x16x32_bf16 v[152:155], v[80:83], v[116:119], v[152:155]
  v_mfma_f32_16x16x32_bf16 v[156:159], v[84:87], v[116:119], v[156:159]
  s_nop 5
  v_pk_mul_f32 v[32:33], v[128:129], v[128:129]
  v_pk_mul_f32 v[34:35], v[130:131], v[130:131]
  v_pk_mul_f32 v[36:37], v[132:133], v[132:133]
  v_pk_mul_f32 v[38:39], v[134:135], v[134:135]
  v_pk_fma_f32 v[32:33], v[32:33], v[18:19], v[16:17]
  v_pk_fma_f32 v[34:35], v[34:35], v[18:19], v[16:17]
  v_pk_fma_f32 v[36:37], v[36:37], v[18:19], v[16:17]
  v_pk_fma_f32 v[38:39], v[38:39], v[18:19], v[16:17]
  v_pk_mul_f32 v[32:33], v[32:33], v[128:129]
  v_pk_mul_f32 v[34:35], v[34:35], v[130:131]
  v_pk_mul_f32 v[36:37], v[36:37], v[132:133]
  v_pk_mul_f32 v[38:39], v[38:39], v[134:135]
  v_exp_f32 v32, v32
  v_exp_f32 v33, v33
  v_mfma_f32_16x16x32_bf16 v[160:163], v[88:91], v[116:119], v[160:163]
  v_exp_f32 v34, v34
  v_exp_f32 v35, v35
  v_exp_f32 v36, v36
  v_exp_f32 v37, v37
  v_exp_f32 v38, v38
  v_exp_f32 v39, v39
  v_pk_mul_f32 v[140:141], v[128:129], v[140:141]
  v_pk_mul_f32 v[142:143], v[130:131], v[142:143]
  v_pk_mul_f32 v[144:145], v[132:133], v[144:145]
  v_pk_mul_f32 v[146:147], v[134:135], v[146:147]
  v_pk_add_f32 v[32:33], v[32:33], v[28:29]
  v_pk_add_f32 v[34:35], v[34:35], v[28:29]
  v_pk_add_f32 v[36:37], v[36:37], v[28:29]
  v_pk_add_f32 v[38:39], v[38:39], v[28:29]
  v_mfma_f32_16x16x32_bf16 v[164:167], v[92:95], v[116:119], v[164:167]
  v_rcp_f32 v32, v32
  v_rcp_f32 v33, v33
  v_rcp_f32 v34, v34
  v_rcp_f32 v35, v35
  v_rcp_f32 v36, v36
  v_rcp_f32 v37, v37
  v_rcp_f32 v38, v38
  v_rcp_f32 v39, v39
  s_nop 0
  v_pk_mul_f32 v[140:141], v[140:141], v[32:33]
  v_pk_mul_f32 v[142:143], v[142:143], v[34:35]
  v_pk_mul_f32 v[144:145], v[144:145], v[36:37]
  v_pk_mul_f32 v[146:147], v[146:147], v[38:39]
  v_cvt_pk_bf16_f32 v64, v140, v141
  v_mfma_f32_16x16x32_bf16 v[168:171], v[96:99], v[116:119], v[168:171]
  v_cvt_pk_bf16_f32 v65, v142, v143
  v_cvt_pk_bf16_f32 v66, v144, v145
  v_cvt_pk_bf16_f32 v67, v146, v147
  buffer_store_dwordx4 v[64:67], v3, s[20:23], s48 offen offset:0 sc1
  v_pk_mul_f32 v[40:41], v[136:137], v[136:137]
  v_pk_mul_f32 v[42:43], v[138:139], v[138:139]
  v_pk_fma_f32 v[40:41], v[40:41], v[18:19], v[16:17]
  v_pk_fma_f32 v[42:43], v[42:43], v[18:19], v[16:17]
  v_pk_mul_f32 v[40:41], v[40:41], v[136:137]
  v_pk_mul_f32 v[42:43], v[42:43], v[138:139]
  v_exp_f32 v40, v40
  v_exp_f32 v41, v41
  v_exp_f32 v42, v42
  v_exp_f32 v43, v43
  v_mfma_f32_16x16x32_bf16 v[172:175], v[100:103], v[116:119], v[172:175]
  v_pk_mul_f32 v[148:149], v[136:137], v[148:149]
  v_pk_mul_f32 v[150:151], v[138:139], v[150:151]
  v_pk_add_f32 v[40:41], v[40:41], v[28:29]
  v_pk_add_f32 v[42:43], v[42:43], v[28:29]
  v_rcp_f32 v40, v40
  v_rcp_f32 v41, v41
  v_rcp_f32 v42, v42
  v_rcp_f32 v43, v43
  s_nop 0
  v_pk_mul_f32 v[148:149], v[148:149], v[40:41]
  v_pk_mul_f32 v[150:151], v[150:151], v[42:43]
  v_cvt_pk_bf16_f32 v68, v148, v149
  v_cvt_pk_bf16_f32 v69, v150, v151
  buffer_store_dwordx2 v[68:69], v3, s[20:23], s49 offen offset:0 sc1
  v_mfma_f32_16x16x32_bf16 v[176:179], v[80:83], v[120:123], v[176:179]
  v_mfma_f32_16x16x32_bf16 v[180:183], v[84:87], v[120:123], v[180:183]
  s_nop 5
  v_pk_mul_f32 v[48:49], v[152:153], v[152:153]
  v_pk_mul_f32 v[50:51], v[154:155], v[154:155]
  v_pk_mul_f32 v[52:53], v[156:157], v[156:157]
  v_pk_mul_f32 v[54:55], v[158:159], v[158:159]
  v_pk_fma_f32 v[48:49], v[48:49], v[18:19], v[16:17]
  v_pk_fma_f32 v[50:51], v[50:51], v[18:19], v[16:17]
  v_pk_fma_f32 v[52:53], v[52:53], v[18:19], v[16:17]
  v_pk_fma_f32 v[54:55], v[54:55], v[18:19], v[16:17]
  v_pk_mul_f32 v[48:49], v[48:49], v[152:153]
  v_pk_mul_f32 v[50:51], v[50:51], v[154:155]
  v_pk_mul_f32 v[52:53], v[52:53], v[156:157]
  v_pk_mul_f32 v[54:55], v[54:55], v[158:159]
  v_exp_f32 v48, v48
  v_exp_f32 v49, v49
  v_mfma_f32_16x16x32_bf16 v[184:187], v[88:91], v[120:123], v[184:187]
  v_exp_f32 v50, v50
  v_exp_f32 v51, v51
  v_exp_f32 v52, v52
  v_exp_f32 v53, v53
  v_exp_f32 v54, v54
  v_exp_f32 v55, v55
  v_pk_mul_f32 v[164:165], v[152:153], v[164:165]
  v_pk_mul_f32 v[166:167], v[154:155], v[166:167]
  v_pk_mul_f32 v[168:169], v[156:157], v[168:169]
  v_pk_mul_f32 v[170:171], v[158:159], v[170:171]
  v_pk_add_f32 v[48:49], v[48:49], v[28:29]
  v_pk_add_f32 v[50:51], v[50:51], v[28:29]
  v_pk_add_f32 v[52:53], v[52:53], v[28:29]
  v_pk_add_f32 v[54:55], v[54:55], v[28:29]
  v_mfma_f32_16x16x32_bf16 v[188:191], v[92:95], v[120:123], v[188:191]
  v_rcp_f32 v48, v48
  v_rcp_f32 v49, v49
  v_rcp_f32 v50, v50
  v_rcp_f32 v51, v51
  v_rcp_f32 v52, v52
  v_rcp_f32 v53, v53
  v_rcp_f32 v54, v54
  v_rcp_f32 v55, v55
  s_nop 0
  v_pk_mul_f32 v[164:165], v[164:165], v[48:49]
  v_pk_mul_f32 v[166:167], v[166:167], v[50:51]
  v_pk_mul_f32 v[168:169], v[168:169], v[52:53]
  v_pk_mul_f32 v[170:171], v[170:171], v[54:55]
  v_cvt_pk_bf16_f32 v72, v164, v165
  v_mfma_f32_16x16x32_bf16 v[192:195], v[96:99], v[120:123], v[192:195]
  v_cvt_pk_bf16_f32 v73, v166, v167
  v_cvt_pk_bf16_f32 v74, v168, v169
  v_cvt_pk_bf16_f32 v75, v170, v171
  buffer_store_dwordx4 v[72:75], v3, s[20:23], s48 offen offset:1024 sc1
  v_pk_mul_f32 v[56:57], v[160:161], v[160:161]
  v_pk_mul_f32 v[58:59], v[162:163], v[162:163]
  v_pk_fma_f32 v[56:57], v[56:57], v[18:19], v[16:17]
  v_pk_fma_f32 v[58:59], v[58:59], v[18:19], v[16:17]
  v_pk_mul_f32 v[56:57], v[56:57], v[160:161]
  v_pk_mul_f32 v[58:59], v[58:59], v[162:163]
  v_exp_f32 v56, v56
  v_exp_f32 v57, v57
  v_exp_f32 v58, v58
  v_exp_f32 v59, v59
  v_mfma_f32_16x16x32_bf16 v[196:199], v[100:103], v[120:123], v[196:199]
  v_pk_mul_f32 v[172:173], v[160:161], v[172:173]
  v_pk_mul_f32 v[174:175], v[162:163], v[174:175]
  v_pk_add_f32 v[56:57], v[56:57], v[28:29]
  v_pk_add_f32 v[58:59], v[58:59], v[28:29]
  v_rcp_f32 v56, v56
  v_rcp_f32 v57, v57
  v_rcp_f32 v58, v58
  v_rcp_f32 v59, v59
  s_nop 0
  v_pk_mul_f32 v[172:173], v[172:173], v[56:57]
  v_pk_mul_f32 v[174:175], v[174:175], v[58:59]
  v_cvt_pk_bf16_f32 v76, v172, v173
  v_cvt_pk_bf16_f32 v77, v174, v175
  buffer_store_dwordx2 v[76:77], v3, s[20:23], s49 offen offset:1024 sc1
  v_mfma_f32_16x16x32_bf16 v[200:203], v[80:83], v[124:127], v[200:203]
  v_mfma_f32_16x16x32_bf16 v[204:207], v[84:87], v[124:127], v[204:207]
  s_nop 5
  v_pk_mul_f32 v[32:33], v[176:177], v[176:177]
  v_pk_mul_f32 v[34:35], v[178:179], v[178:179]
  v_pk_mul_f32 v[36:37], v[180:181], v[180:181]
  v_pk_mul_f32 v[38:39], v[182:183], v[182:183]
  v_pk_fma_f32 v[32:33], v[32:33], v[18:19], v[16:17]
  v_pk_fma_f32 v[34:35], v[34:35], v[18:19], v[16:17]
  v_pk_fma_f32 v[36:37], v[36:37], v[18:19], v[16:17]
  v_pk_fma_f32 v[38:39], v[38:39], v[18:19], v[16:17]
  v_pk_mul_f32 v[32:33], v[32:33], v[176:177]
  v_pk_mul_f32 v[34:35], v[34:35], v[178:179]
  v_pk_mul_f32 v[36:37], v[36:37], v[180:181]
  v_pk_mul_f32 v[38:39], v[38:39], v[182:183]
  v_exp_f32 v32, v32
  v_exp_f32 v33, v33
  v_mfma_f32_16x16x32_bf16 v[208:211], v[88:91], v[124:127], v[208:211]
  v_exp_f32 v34, v34
  v_exp_f32 v35, v35
  v_exp_f32 v36, v36
  v_exp_f32 v37, v37
  v_exp_f32 v38, v38
  v_exp_f32 v39, v39
  v_pk_mul_f32 v[188:189], v[176:177], v[188:189]
  v_pk_mul_f32 v[190:191], v[178:179], v[190:191]
  v_pk_mul_f32 v[192:193], v[180:181], v[192:193]
  v_pk_mul_f32 v[194:195], v[182:183], v[194:195]
  v_pk_add_f32 v[32:33], v[32:33], v[28:29]
  v_pk_add_f32 v[34:35], v[34:35], v[28:29]
  v_pk_add_f32 v[36:37], v[36:37], v[28:29]
  v_pk_add_f32 v[38:39], v[38:39], v[28:29]
  v_mfma_f32_16x16x32_bf16 v[212:215], v[92:95], v[124:127], v[212:215]
  v_rcp_f32 v32, v32
  v_rcp_f32 v33, v33
  v_rcp_f32 v34, v34
  v_rcp_f32 v35, v35
  v_rcp_f32 v36, v36
  v_rcp_f32 v37, v37
  v_rcp_f32 v38, v38
  v_rcp_f32 v39, v39
  s_nop 0
  v_pk_mul_f32 v[188:189], v[188:189], v[32:33]
  v_pk_mul_f32 v[190:191], v[190:191], v[34:35]
  v_pk_mul_f32 v[192:193], v[192:193], v[36:37]
  v_pk_mul_f32 v[194:195], v[194:195], v[38:39]
  v_cvt_pk_bf16_f32 v64, v188, v189
  v_mfma_f32_16x16x32_bf16 v[216:219], v[96:99], v[124:127], v[216:219]
  v_cvt_pk_bf16_f32 v65, v190, v191
  v_cvt_pk_bf16_f32 v66, v192, v193
  v_cvt_pk_bf16_f32 v67, v194, v195
  buffer_store_dwordx4 v[64:67], v3, s[20:23], s48 offen offset:2048 sc1
  v_pk_mul_f32 v[40:41], v[184:185], v[184:185]
  v_pk_mul_f32 v[42:43], v[186:187], v[186:187]
  v_pk_fma_f32 v[40:41], v[40:41], v[18:19], v[16:17]
  v_pk_fma_f32 v[42:43], v[42:43], v[18:19], v[16:17]
  v_pk_mul_f32 v[40:41], v[40:41], v[184:185]
  v_pk_mul_f32 v[42:43], v[42:43], v[186:187]
  v_exp_f32 v40, v40
  v_exp_f32 v41, v41
  v_exp_f32 v42, v42
  v_exp_f32 v43, v43
  v_mfma_f32_16x16x32_bf16 v[220:223], v[100:103], v[124:127], v[220:223]
  v_pk_mul_f32 v[196:197], v[184:185], v[196:197]
  v_pk_mul_f32 v[198:199], v[186:187], v[198:199]
  v_pk_add_f32 v[40:41], v[40:41], v[28:29]
  v_pk_add_f32 v[42:43], v[42:43], v[28:29]
  v_rcp_f32 v40, v40
  v_rcp_f32 v41, v41
  v_rcp_f32 v42, v42
  v_rcp_f32 v43, v43
  s_nop 0
  v_pk_mul_f32 v[196:197], v[196:197], v[40:41]
  v_pk_mul_f32 v[198:199], v[198:199], v[42:43]
  v_cvt_pk_bf16_f32 v68, v196, v197
  v_cvt_pk_bf16_f32 v69, v198, v199
  buffer_store_dwordx2 v[68:69], v3, s[20:23], s49 offen offset:2048 sc1
  s_nop 7
  v_pk_mul_f32 v[48:49], v[200:201], v[200:201]
  v_pk_mul_f32 v[50:51], v[202:203], v[202:203]
  v_pk_mul_f32 v[52:53], v[204:205], v[204:205]
  v_pk_mul_f32 v[54:55], v[206:207], v[206:207]
  v_pk_fma_f32 v[48:49], v[48:49], v[18:19], v[16:17]
  v_pk_fma_f32 v[50:51], v[50:51], v[18:19], v[16:17]
  v_pk_fma_f32 v[52:53], v[52:53], v[18:19], v[16:17]
  v_pk_fma_f32 v[54:55], v[54:55], v[18:19], v[16:17]
  v_pk_mul_f32 v[48:49], v[48:49], v[200:201]
  v_pk_mul_f32 v[50:51], v[50:51], v[202:203]
  v_pk_mul_f32 v[52:53], v[52:53], v[204:205]
  v_pk_mul_f32 v[54:55], v[54:55], v[206:207]
  v_exp_f32 v48, v48
  v_exp_f32 v49, v49
  v_exp_f32 v50, v50
  v_exp_f32 v51, v51
  v_exp_f32 v52, v52
  v_exp_f32 v53, v53
  v_exp_f32 v54, v54
  v_exp_f32 v55, v55
  v_pk_mul_f32 v[212:213], v[200:201], v[212:213]
  v_pk_mul_f32 v[214:215], v[202:203], v[214:215]
  v_pk_mul_f32 v[216:217], v[204:205], v[216:217]
  v_pk_mul_f32 v[218:219], v[206:207], v[218:219]
  v_pk_add_f32 v[48:49], v[48:49], v[28:29]
  v_pk_add_f32 v[50:51], v[50:51], v[28:29]
  v_pk_add_f32 v[52:53], v[52:53], v[28:29]
  v_pk_add_f32 v[54:55], v[54:55], v[28:29]
  v_rcp_f32 v48, v48
  v_rcp_f32 v49, v49
  v_rcp_f32 v50, v50
  v_rcp_f32 v51, v51
  v_rcp_f32 v52, v52
  v_rcp_f32 v53, v53
  v_rcp_f32 v54, v54
  v_rcp_f32 v55, v55
  s_nop 0
  v_pk_mul_f32 v[212:213], v[212:213], v[48:49]
  v_pk_mul_f32 v[214:215], v[214:215], v[50:51]
  v_pk_mul_f32 v[216:217], v[216:217], v[52:53]
  v_pk_mul_f32 v[218:219], v[218:219], v[54:55]
  v_cvt_pk_bf16_f32 v72, v212, v213
  v_cvt_pk_bf16_f32 v73, v214, v215
  v_cvt_pk_bf16_f32 v74, v216, v217
  v_cvt_pk_bf16_f32 v75, v218, v219
  buffer_store_dwordx4 v[72:75], v3, s[20:23], s48 offen offset:3072 sc1
  v_pk_mul_f32 v[56:57], v[208:209], v[208:209]
  v_pk_mul_f32 v[58:59], v[210:211], v[210:211]
  v_pk_fma_f32 v[56:57], v[56:57], v[18:19], v[16:17]
  v_pk_fma_f32 v[58:59], v[58:59], v[18:19], v[16:17]
  v_pk_mul_f32 v[56:57], v[56:57], v[208:209]
  v_pk_mul_f32 v[58:59], v[58:59], v[210:211]
  v_exp_f32 v56, v56
  v_exp_f32 v57, v57
  v_exp_f32 v58, v58
  v_exp_f32 v59, v59
  v_pk_mul_f32 v[220:221], v[208:209], v[220:221]
  v_pk_mul_f32 v[222:223], v[210:211], v[222:223]
  v_pk_add_f32 v[56:57], v[56:57], v[28:29]
  v_pk_add_f32 v[58:59], v[58:59], v[28:29]
  v_rcp_f32 v56, v56
  v_rcp_f32 v57, v57
  v_rcp_f32 v58, v58
  v_rcp_f32 v59, v59
  s_nop 0
  v_pk_mul_f32 v[220:221], v[220:221], v[56:57]
  v_pk_mul_f32 v[222:223], v[222:223], v[58:59]
  v_cvt_pk_bf16_f32 v76, v220, v221
  v_cvt_pk_bf16_f32 v77, v222, v223
  buffer_store_dwordx2 v[76:77], v3, s[20:23], s49 offen offset:3072 sc1
  s_branch g3_p2
g3_p2:
  s_load_dwordx2 s[4:5], s[0:1], 64
  s_load_dwordx2 s[6:7], s[0:1], 88
  s_lshl_b32 s38, s36, 1
  s_lshr_b32 s39, s37, 4
  s_add_u32 s38, s38, s39
  s_lshl_b32 s38, s38, 7
  s_add_u32 s60, s32, 0x88000
  s_addc_u32 s61, s33, 0
  s_mov_b32 s62, 0x800
  s_mov_b32 s63, 0x20000
  s_waitcnt vmcnt(0) lgkmcnt(0)
  s_barrier
  s_cmp_lg_u32 s28, 0
  s_cbranch_scc1 g4_f_nosig
  v_mov_b32 v20, 1
  v_mov_b32 v21, s38
  s_mov_b64 exec, 1
  buffer_atomic_add v20, v21, s[60:63], 0 offen sc1
  s_mov_b64 exec, -1
g4_f_nosig:
  s_and_b32 s34, s2, 7
  s_lshr_b32 s35, s2, 3
  s_and_b32 s56, s35, 1
  s_lshr_b32 s35, s35, 1
  s_and_b32 s36, s34, 1
  s_lshl_b32 s36, s36, 2
  s_and_b32 s37, s35, 3
  s_add_u32 s36, s36, s37
  s_lshr_b32 s37, s34, 1
  s_lshl_b32 s37, s37, 2
  s_lshr_b32 s38, s35, 2
  s_add_u32 s37, s37, s38
  v_lshrrev_b32 v16, 4, v0
  v_lshlrev_b32 v3, 4, v0
  s_cmp_ge_u32 s28, 4
  s_cbranch_scc1 g4_f_prod
  v_and_b32 v17, 1, v16
  v_lshlrev_b32 v17, 2, v17
  v_bfe_u32 v18, v0, 2, 2
  v_add_u32 v17, v17, v18
  s_mov_b32 s39, 1056
  v_mul_lo_u32 v17, v17, s39
  v_lshrrev_b32 v18, 1, v16
  v_lshlrev_b32 v18, 8, v18
  v_add_u32 v17, v17, v18
  v_and_b32 v18, 3, v0
  v_lshlrev_b32 v18, 3, v18
  v_add_u32 v17, v17, v18
  s_and_b32 s39, s28, 1
  s_lshl_b32 s39, s39, 7
  v_add_u32 v4, s39, v17
  s_lshr_b32 s39, s28, 1
  s_lshl_b32 s39, s39, 13
  s_add_u32 s39, s39, 16896
  s_lshl_b32 s38, s56, 11
  s_add_u32 s42, s39, s38
  v_add_u32 v5, s42, v3
  s_xor_b32 s38, s38, 2048
  s_add_u32 s42, s39, s38
  v_add_u32 v6, s42, v3
  v_mov_b32 v24, 0
  v_mov_b32 v25, 0
  v_mov_b32 v26, 0
  v_mov_b32 v27, 0
  s_nop 1
  v_mfma_f32_32x32x16_bf16 v[160:175], v[24:27], v[24:27], 0
  v_mfma_f32_32x32x16_bf16 v[176:191], v[24:27], v[24:27], 0
  v_mfma_f32_32x32x16_bf16 v[192:207], v[24:27], v[24:27], 0
  v_mfma_f32_32x32x16_bf16 v[208:223], v[24:27], v[24:27], 0
  v_and_b32 v17, 15, v0
  v_lshlrev_b32 v17, 11, v17
  v_and_b32 v18, 1, v16
  v_lshlrev_b32 v18, 5, v18
  v_add_u32 v17, v17, v18
  v_lshrrev_b32 v18, 1, v16
  v_lshlrev_b32 v18, 4, v18
  v_add_u32 v17, v17, v18
  s_and_b32 s39, s28, 1
  s_lshl_b32 s39, s39, 7
  s_lshr_b32 s38, s28, 1
  s_lshl_b32 s38, s38, 17
  s_add_u32 s39, s39, s38
  s_lshl_b32 s38, s56, 16
  s_add_u32 s39, s39, s38
  v_add_u32 v10, s39, v17
  v_and_b32 v17, 1, v16
  v_lshlrev_b32 v17, 6, v17
  v_lshrrev_b32 v18, 1, v16
  v_lshlrev_b32 v18, 5, v18
  v_add_u32 v17, v17, v18
  s_and_b32 s39, s28, 1
  s_lshl_b32 s39, s39, 8
  v_add_u32 v11, s39, v17
  s_waitcnt lgkmcnt(0)
  s_lshl_b32 s39, s37, 18
  s_lshl_b32 s38, s36, 8
  s_add_u32 s39, s39, s38
  s_sub_u32 s38, 4194304, s39
  s_add_u32 s16, s6, s39
  s_addc_u32 s17, s7, 0
  s_mov_b32 s18, s38
  s_mov_b32 s19, 0x20000
  s_add_u32 s20, s32, s39
  s_addc_u32 s21, s33, 0
  s_add_u32 s20, s20, 0xd00000
  s_addc_u32 s21, s21, 0
  s_mov_b32 s22, s38
  s_mov_b32 s23, 0x20000
  s_lshl_b32 s39, s36, 9
  s_add_u32 s24, s32, s39
  s_addc_u32 s25, s33, 0
  s_add_u32 s24, s24, 0x6d000
  s_addc_u32 s25, s25, 0
  s_mov_b32 s26, 0x200
  s_mov_b32 s27, 0x20000
  s_lshl_b32 s39, s37, 3
  s_add_u32 s39, s39, s36
  s_lshl_b32 s39, s39, 1
  s_xor_b32 s38, s56, 1
  s_add_u32 s38, s38, s39
  s_lshl_b32 s38, s38, 2
  s_add_u32 s38, s38, s28
  s_lshl_b32 s38, s38, 13
  s_add_u32 s44, s32, s38
  s_addc_u32 s45, s33, 0
  s_add_u32 s44, s44, 0x2400000
  s_addc_u32 s45, s45, 0
  s_mov_b32 s46, 0x2000
  s_mov_b32 s47, 0x20000
  s_add_u32 s38, s39, s56
  s_lshl_b32 s38, s38, 2
  s_add_u32 s38, s38, s28
  s_lshl_b32 s38, s38, 13
  s_add_u32 s48, s32, s38
  s_addc_u32 s49, s33, 0
  s_add_u32 s48, s48, 0x2400000
  s_addc_u32 s49, s49, 0
  s_mov_b32 s50, 0x2000
  s_mov_b32 s51, 0x20000
  s_add_u32 s52, s32, 0x80000
  s_addc_u32 s53, s33, 0
  s_mov_b32 s54, 0x8000
  s_mov_b32 s55, 0x20000
  s_mov_b32 s40, 0
  v_add_u32 v7, s40, v4
  v_add_u32 v8, s40, v5
  v_add_u32 v9, s40, v6
  s_barrier
  s_barrier
  ds_read_b128 v[64:67], v8 offset:0
  ds_read_b64_tr_b16 v[32:33], v7 offset:0
  ds_read_b64_tr_b16 v[34:35], v7 offset:512
  ds_read_b128 v[68:71], v8 offset:1024
  ds_read_b64_tr_b16 v[36:37], v7 offset:32
  ds_read_b64_tr_b16 v[38:39], v7 offset:544
  ds_read_b128 v[72:75], v9 offset:0
  ds_read_b64_tr_b16 v[40:41], v7 offset:64
  ds_read_b64_tr_b16 v[42:43], v7 offset:576
  ds_read_b128 v[76:79], v9 offset:1024
  ds_read_b64_tr_b16 v[44:45], v7 offset:96
  ds_read_b64_tr_b16 v[46:47], v7 offset:608
  ds_read_b128 v[80:83], v8 offset:4096
  ds_read_b64_tr_b16 v[48:49], v7 offset:8448
  ds_read_b64_tr_b16 v[50:51], v7 offset:8960
  ds_read_b128 v[84:87], v8 offset:5120
  ds_read_b64_tr_b16 v[52:53], v7 offset:8480
  ds_read_b64_tr_b16 v[54:55], v7 offset:8992
  ds_read_b128 v[88:91], v9 offset:4096
  ds_read_b64_tr_b16 v[56:57], v7 offset:8512
  ds_read_b64_tr_b16 v[58:59], v7 offset:9024
  ds_read_b128 v[92:95], v9 offset:5120
  ds_read_b64_tr_b16 v[60:61], v7 offset:8544
  ds_read_b64_tr_b16 v[62:63], v7 offset:9056
  s_mov_b32 s38, 0
  buffer_load_dwordx4 v[224:227], v10, s[20:23], s38 offen offset:0
  s_mov_b32 s38, 0
  buffer_load_dwordx4 v[228:231], v10, s[20:23], s38 offen offset:64
  s_mov_b32 s38, 32768
  buffer_load_dwordx4 v[232:235], v10, s[20:23], s38 offen offset:0
  s_mov_b32 s38, 32768
  buffer_load_dwordx4 v[236:239], v10, s[20:23], s38 offen offset:64
  buffer_load_dwordx4 v[240:243], v11, s[24:27], 0 offen offset:0
  buffer_load_dwordx4 v[244:247], v11, s[24:27], 0 offen offset:16
  buffer_load_dwordx4 v[248:251], v11, s[24:27], 0 offen offset:128
  buffer_load_dwordx4 v[252:255], v11, s[24:27], 0 offen offset:144
  s_mov_b32 s40, 33280
  v_add_u32 v7, s40, v4
  v_add_u32 v8, s40, v5
  v_add_u32 v9, s40, v6
  s_mov_b32 s31, 14
g4_f_cloop:
  s_waitcnt lgkmcnt(0)
  s_barrier
  v_mfma_f32_16x16x32_bf16 v[160:163], v[32:35], v[64:67], v[160:163]
  ds_read_b128 v[128:131], v8 offset:0
  v_mfma_f32_16x16x32_bf16 v[164:167], v[36:39], v[64:67], v[164:167]
  ds_read_b64_tr_b16 v[96:97], v7 offset:0
  v_mfma_f32_16x16x32_bf16 v[168:171], v[40:43], v[64:67], v[168:171]
  ds_read_b64_tr_b16 v[98:99], v7 offset:512
  v_mfma_f32_16x16x32_bf16 v[172:175], v[44:47], v[64:67], v[172:175]
  ds_read_b128 v[132:135], v8 offset:1024
  v_mfma_f32_16x16x32_bf16 v[176:179], v[32:35], v[68:71], v[176:179]
  ds_read_b64_tr_b16 v[100:101], v7 offset:32
  v_mfma_f32_16x16x32_bf16 v[180:183], v[36:39], v[68:71], v[180:183]
  ds_read_b64_tr_b16 v[102:103], v7 offset:544
  v_mfma_f32_16x16x32_bf16 v[184:187], v[40:43], v[68:71], v[184:187]
  ds_read_b128 v[136:139], v9 offset:0
  v_mfma_f32_16x16x32_bf16 v[188:191], v[44:47], v[68:71], v[188:191]
  ds_read_b64_tr_b16 v[104:105], v7 offset:64
  v_mfma_f32_16x16x32_bf16 v[192:195], v[32:35], v[72:75], v[192:195]
  ds_read_b64_tr_b16 v[106:107], v7 offset:576
  v_mfma_f32_16x16x32_bf16 v[196:199], v[36:39], v[72:75], v[196:199]
  ds_read_b128 v[140:143], v9 offset:1024
  v_mfma_f32_16x16x32_bf16 v[200:203], v[40:43], v[72:75], v[200:203]
  ds_read_b64_tr_b16 v[108:109], v7 offset:96
  v_mfma_f32_16x16x32_bf16 v[204:207], v[44:47], v[72:75], v[204:207]
  ds_read_b64_tr_b16 v[110:111], v7 offset:608
  v_mfma_f32_16x16x32_bf16 v[208:211], v[32:35], v[76:79], v[208:211]
  ds_read_b128 v[144:147], v8 offset:4096
  v_mfma_f32_16x16x32_bf16 v[212:215], v[36:39], v[76:79], v[212:215]
  ds_read_b64_tr_b16 v[112:113], v7 offset:8448
  v_mfma_f32_16x16x32_bf16 v[216:219], v[40:43], v[76:79], v[216:219]
  ds_read_b64_tr_b16 v[114:115], v7 offset:8960
  v_mfma_f32_16x16x32_bf16 v[220:223], v[44:47], v[76:79], v[220:223]
  ds_read_b128 v[148:151], v8 offset:5120
  v_mfma_f32_16x16x32_bf16 v[160:163], v[48:51], v[80:83], v[160:163]
  ds_read_b64_tr_b16 v[116:117], v7 offset:8480
  v_mfma_f32_16x16x32_bf16 v[164:167], v[52:55], v[80:83], v[164:167]
  ds_read_b64_tr_b16 v[118:119], v7 offset:8992
  v_mfma_f32_16x16x32_bf16 v[168:171], v[56:59], v[80:83], v[168:171]
  ds_read_b128 v[152:155], v9 offset:4096
  v_mfma_f32_16x16x32_bf16 v[172:175], v[60:63], v[80:83], v[172:175]
  ds_read_b64_tr_b16 v[120:121], v7 offset:8512
  v_mfma_f32_16x16x32_bf16 v[176:179], v[48:51], v[84:87], v[176:179]
  ds_read_b64_tr_b16 v[122:123], v7 offset:9024
  v_mfma_f32_16x16x32_bf16 v[180:183], v[52:55], v[84:87], v[180:183]
  ds_read_b128 v[156:159], v9 offset:5120
  v_mfma_f32_16x16x32_bf16 v[184:187], v[56:59], v[84:87], v[184:187]
  ds_read_b64_tr_b16 v[124:125], v7 offset:8544
  v_mfma_f32_16x16x32_bf16 v[188:191], v[60:63], v[84:87], v[188:191]
  ds_read_b64_tr_b16 v[126:127], v7 offset:9056
  v_mfma_f32_16x16x32_bf16 v[192:195], v[48:51], v[88:91], v[192:195]
  v_mfma_f32_16x16x32_bf16 v[196:199], v[52:55], v[88:91], v[196:199]
  s_add_u32 s40, s40, 33280
  s_cmp_eq_u32 s40, 133120
  s_cselect_b32 s40, 0, s40
  v_mfma_f32_16x16x32_bf16 v[200:203], v[56:59], v[88:91], v[200:203]
  v_mfma_f32_16x16x32_bf16 v[204:207], v[60:63], v[88:91], v[204:207]
  v_add_u32 v7, s40, v4
  v_add_u32 v8, s40, v5
  v_add_u32 v9, s40, v6
  v_mfma_f32_16x16x32_bf16 v[208:211], v[48:51], v[92:95], v[208:211]
  v_mfma_f32_16x16x32_bf16 v[212:215], v[52:55], v[92:95], v[212:215]
  v_mfma_f32_16x16x32_bf16 v[216:219], v[56:59], v[92:95], v[216:219]
  v_mfma_f32_16x16x32_bf16 v[220:223], v[60:63], v[92:95], v[220:223]
  s_waitcnt lgkmcnt(0)
  s_barrier
  v_mfma_f32_16x16x32_bf16 v[160:163], v[96:99], v[128:131], v[160:163]
  ds_read_b128 v[64:67], v8 offset:0
  v_mfma_f32_16x16x32_bf16 v[164:167], v[100:103], v[128:131], v[164:167]
  ds_read_b64_tr_b16 v[32:33], v7 offset:0
  v_mfma_f32_16x16x32_bf16 v[168:171], v[104:107], v[128:131], v[168:171]
  ds_read_b64_tr_b16 v[34:35], v7 offset:512
  v_mfma_f32_16x16x32_bf16 v[172:175], v[108:111], v[128:131], v[172:175]
  ds_read_b128 v[68:71], v8 offset:1024
  v_mfma_f32_16x16x32_bf16 v[176:179], v[96:99], v[132:135], v[176:179]
  ds_read_b64_tr_b16 v[36:37], v7 offset:32
  v_mfma_f32_16x16x32_bf16 v[180:183], v[100:103], v[132:135], v[180:183]
  ds_read_b64_tr_b16 v[38:39], v7 offset:544
  v_mfma_f32_16x16x32_bf16 v[184:187], v[104:107], v[132:135], v[184:187]
  ds_read_b128 v[72:75], v9 offset:0
  v_mfma_f32_16x16x32_bf16 v[188:191], v[108:111], v[132:135], v[188:191]
  ds_read_b64_tr_b16 v[40:41], v7 offset:64
  v_mfma_f32_16x16x32_bf16 v[192:195], v[96:99], v[136:139], v[192:195]
  ds_read_b64_tr_b16 v[42:43], v7 offset:576
  v_mfma_f32_16x16x32_bf16 v[196:199], v[100:103], v[136:139], v[196:199]
  ds_read_b128 v[76:79], v9 offset:1024
  v_mfma_f32_16x16x32_bf16 v[200:203], v[104:107], v[136:139], v[200:203]
  ds_read_b64_tr_b16 v[44:45], v7 offset:96
  v_mfma_f32_16x16x32_bf16 v[204:207], v[108:111], v[136:139], v[204:207]
  ds_read_b64_tr_b16 v[46:47], v7 offset:608
  v_mfma_f32_16x16x32_bf16 v[208:211], v[96:99], v[140:143], v[208:211]
  ds_read_b128 v[80:83], v8 offset:4096
  v_mfma_f32_16x16x32_bf16 v[212:215], v[100:103], v[140:143], v[212:215]
  ds_read_b64_tr_b16 v[48:49], v7 offset:8448
  v_mfma_f32_16x16x32_bf16 v[216:219], v[104:107], v[140:143], v[216:219]
  ds_read_b64_tr_b16 v[50:51], v7 offset:8960
  v_mfma_f32_16x16x32_bf16 v[220:223], v[108:111], v[140:143], v[220:223]
  ds_read_b128 v[84:87], v8 offset:5120
  v_mfma_f32_16x16x32_bf16 v[160:163], v[112:115], v[144:147], v[160:163]
  ds_read_b64_tr_b16 v[52:53], v7 offset:8480
  v_mfma_f32_16x16x32_bf16 v[164:167], v[116:119], v[144:147], v[164:167]
  ds_read_b64_tr_b16 v[54:55], v7 offset:8992
  v_mfma_f32_16x16x32_bf16 v[168:171], v[120:123], v[144:147], v[168:171]
  ds_read_b128 v[88:91], v9 offset:4096
  v_mfma_f32_16x16x32_bf16 v[172:175], v[124:127], v[144:147], v[172:175]
  ds_read_b64_tr_b16 v[56:57], v7 offset:8512
  v_mfma_f32_16x16x32_bf16 v[176:179], v[112:115], v[148:151], v[176:179]
  ds_read_b64_tr_b16 v[58:59], v7 offset:9024
  v_mfma_f32_16x16x32_bf16 v[180:183], v[116:119], v[148:151], v[180:183]
  ds_read_b128 v[92:95], v9 offset:5120
  v_mfma_f32_16x16x32_bf16 v[184:187], v[120:123], v[148:151], v[184:187]
  ds_read_b64_tr_b16 v[60:61], v7 offset:8544
  v_mfma_f32_16x16x32_bf16 v[188:191], v[124:127], v[148:151], v[188:191]
  ds_read_b64_tr_b16 v[62:63], v7 offset:9056
  v_mfma_f32_16x16x32_bf16 v[192:195], v[112:115], v[152:155], v[192:195]
  v_mfma_f32_16x16x32_bf16 v[196:199], v[116:119], v[152:155], v[196:199]
  s_add_u32 s40, s40, 33280
  s_cmp_eq_u32 s40, 133120
  s_cselect_b32 s40, 0, s40
  v_mfma_f32_16x16x32_bf16 v[200:203], v[120:123], v[152:155], v[200:203]
  v_mfma_f32_16x16x32_bf16 v[204:207], v[124:127], v[152:155], v[204:207]
  v_add_u32 v7, s40, v4
  v_add_u32 v8, s40, v5
  v_add_u32 v9, s40, v6
  v_mfma_f32_16x16x32_bf16 v[208:211], v[112:115], v[156:159], v[208:211]
  v_mfma_f32_16x16x32_bf16 v[212:215], v[116:119], v[156:159], v[212:215]
  v_mfma_f32_16x16x32_bf16 v[216:219], v[120:123], v[156:159], v[216:219]
  v_mfma_f32_16x16x32_bf16 v[220:223], v[124:127], v[156:159], v[220:223]
  s_sub_u32 s31, s31, 1
  s_cmp_lg_u32 s31, 0
  s_cbranch_scc1 g4_f_cloop
  s_nop 7
  buffer_store_dwordx4 v[192:195], v3, s[44:47], 0 offen offset:0 sc1
  buffer_store_dwordx4 v[196:199], v3, s[44:47], 0 offen offset:1024 sc1
  buffer_store_dwordx4 v[200:203], v3, s[44:47], 0 offen offset:2048 sc1
  buffer_store_dwordx4 v[204:207], v3, s[44:47], 0 offen offset:3072 sc1
  s_mov_b32 s39, 4096
  buffer_store_dwordx4 v[208:211], v3, s[44:47], s39 offen offset:0 sc1
  buffer_store_dwordx4 v[212:215], v3, s[44:47], s39 offen offset:1024 sc1
  buffer_store_dwordx4 v[216:219], v3, s[44:47], s39 offen offset:2048 sc1
  buffer_store_dwordx4 v[220:223], v3, s[44:47], s39 offen offset:3072 sc1
  s_waitcnt vmcnt(0) lgkmcnt(0)
  s_barrier
  s_cmp_lg_u32 s28, 0
  s_cbranch_scc1 g4_f_nopoll
  s_lshl_b32 s38, s2, 7
  v_mov_b32 v20, 1
  v_mov_b32 v21, s38
  s_mov_b64 exec, 1
  buffer_store_dword v20, v21, s[52:55], 0 offen sc1
  s_xor_b32 s42, s2, 8
  s_lshl_b32 s38, s42, 7
  s_mov_b32 s39, 1
  v_mov_b32 v21, s38
  s_mov_b32 s43, 1048576
g4_f_poll:
  buffer_load_dword v22, v21, s[52:55], 0 offen sc1
  s_waitcnt vmcnt(0)
  v_readfirstlane_b32 s42, v22
  s_and_b32 s42, s42, s39
  s_cbranch_scc1 g4_f_got
  s_sub_u32 s43, s43, 1
  s_cmp_lg_u32 s43, 0
  s_cbranch_scc0 g4_f_got
  s_sleep 1
  s_branch g4_f_poll
g4_f_got:
  s_mov_b64 exec, -1
g4_f_nopoll:
  s_barrier
  buffer_load_dwordx4 v[32:35], v3, s[48:51], 0 offen offset:0 sc1
  buffer_load_dwordx4 v[36:39], v3, s[48:51], 0 offen offset:1024 sc1
  buffer_load_dwordx4 v[40:43], v3, s[48:51], 0 offen offset:2048 sc1
  buffer_load_dwordx4 v[44:47], v3, s[48:51], 0 offen offset:3072 sc1
  s_mov_b32 s39, 4096
  buffer_load_dwordx4 v[48:51], v3, s[48:51], s39 offen offset:0 sc1
  buffer_load_dwordx4 v[52:55], v3, s[48:51], s39 offen offset:1024 sc1
  buffer_load_dwordx4 v[56:59], v3, s[48:51], s39 offen offset:2048 sc1
  buffer_load_dwordx4 v[60:63], v3, s[48:51], s39 offen offset:3072 sc1
  s_waitcnt vmcnt(4)
  v_pk_add_f32 v[160:161], v[160:161], v[32:33]
  v_pk_add_f32 v[162:163], v[162:163], v[34:35]
  v_pk_add_f32 v[164:165], v[164:165], v[36:37]
  v_pk_add_f32 v[166:167], v[166:167], v[38:39]
  v_pk_add_f32 v[168:169], v[168:169], v[40:41]
  v_pk_add_f32 v[170:171], v[170:171], v[42:43]
  v_pk_add_f32 v[172:173], v[172:173], v[44:45]
  v_pk_add_f32 v[174:175], v[174:175], v[46:47]
  s_nop 1
  v_permlane16_swap_b32 v160, v164
  v_permlane16_swap_b32 v161, v165
  v_permlane16_swap_b32 v162, v166
  v_permlane16_swap_b32 v163, v167
  v_permlane16_swap_b32 v168, v172
  v_permlane16_swap_b32 v169, v173
  v_permlane16_swap_b32 v170, v174
  v_permlane16_swap_b32 v171, v175
  v_lshlrev_b32 v96, 16, v224
  v_and_b32 v97, 0xffff0000, v224
  v_lshlrev_b32 v98, 16, v225
  v_and_b32 v99, 0xffff0000, v225
  v_lshlrev_b32 v100, 16, v226
  v_and_b32 v101, 0xffff0000, v226
  v_lshlrev_b32 v102, 16, v227
  v_and_b32 v103, 0xffff0000, v227
  v_pk_fma_f32 v[96:97], v[160:161], v[240:241], v[96:97]
  v_pk_fma_f32 v[98:99], v[162:163], v[242:243], v[98:99]
  v_pk_fma_f32 v[100:101], v[164:165], v[244:245], v[100:101]
  v_pk_fma_f32 v[102:103], v[166:167], v[246:247], v[102:103]
  v_cvt_pk_bf16_f32 v224, v96, v97
  v_cvt_pk_bf16_f32 v225, v98, v99
  v_cvt_pk_bf16_f32 v226, v100, v101
  v_cvt_pk_bf16_f32 v227, v102, v103
  s_mov_b32 s38, 0
  buffer_store_dwordx4 v[224:227], v10, s[16:19], s38 offen offset:0 sc1
  v_lshlrev_b32 v104, 16, v228
  v_and_b32 v105, 0xffff0000, v228
  v_lshlrev_b32 v106, 16, v229
  v_and_b32 v107, 0xffff0000, v229
  v_lshlrev_b32 v108, 16, v230
  v_and_b32 v109, 0xffff0000, v230
  v_lshlrev_b32 v110, 16, v231
  v_and_b32 v111, 0xffff0000, v231
  v_pk_fma_f32 v[104:105], v[168:169], v[248:249], v[104:105]
  v_pk_fma_f32 v[106:107], v[170:171], v[250:251], v[106:107]
  v_pk_fma_f32 v[108:109], v[172:173], v[252:253], v[108:109]
  v_pk_fma_f32 v[110:111], v[174:175], v[254:255], v[110:111]
  v_cvt_pk_bf16_f32 v228, v104, v105
  v_cvt_pk_bf16_f32 v229, v106, v107
  v_cvt_pk_bf16_f32 v230, v108, v109
  v_cvt_pk_bf16_f32 v231, v110, v111
  s_mov_b32 s38, 0
  buffer_store_dwordx4 v[228:231], v10, s[16:19], s38 offen offset:64 sc1
  s_waitcnt vmcnt(2)
  v_pk_add_f32 v[176:177], v[176:177], v[48:49]
  v_pk_add_f32 v[178:179], v[178:179], v[50:51]
  v_pk_add_f32 v[180:181], v[180:181], v[52:53]
  v_pk_add_f32 v[182:183], v[182:183], v[54:55]
  v_pk_add_f32 v[184:185], v[184:185], v[56:57]
  v_pk_add_f32 v[186:187], v[186:187], v[58:59]
  v_pk_add_f32 v[188:189], v[188:189], v[60:61]
  v_pk_add_f32 v[190:191], v[190:191], v[62:63]
  s_nop 1
  v_permlane16_swap_b32 v176, v180
  v_permlane16_swap_b32 v177, v181
  v_permlane16_swap_b32 v178, v182
  v_permlane16_swap_b32 v179, v183
  v_permlane16_swap_b32 v184, v188
  v_permlane16_swap_b32 v185, v189
  v_permlane16_swap_b32 v186, v190
  v_permlane16_swap_b32 v187, v191
  v_lshlrev_b32 v112, 16, v232
  v_and_b32 v113, 0xffff0000, v232
  v_lshlrev_b32 v114, 16, v233
  v_and_b32 v115, 0xffff0000, v233
  v_lshlrev_b32 v116, 16, v234
  v_and_b32 v117, 0xffff0000, v234
  v_lshlrev_b32 v118, 16, v235
  v_and_b32 v119, 0xffff0000, v235
  v_pk_fma_f32 v[112:113], v[176:177], v[240:241], v[112:113]
  v_pk_fma_f32 v[114:115], v[178:179], v[242:243], v[114:115]
  v_pk_fma_f32 v[116:117], v[180:181], v[244:245], v[116:117]
  v_pk_fma_f32 v[118:119], v[182:183], v[246:247], v[118:119]
  v_cvt_pk_bf16_f32 v232, v112, v113
  v_cvt_pk_bf16_f32 v233, v114, v115
  v_cvt_pk_bf16_f32 v234, v116, v117
  v_cvt_pk_bf16_f32 v235, v118, v119
  s_mov_b32 s38, 32768
  buffer_store_dwordx4 v[232:235], v10, s[16:19], s38 offen offset:0 sc1
  v_lshlrev_b32 v120, 16, v236
  v_and_b32 v121, 0xffff0000, v236
  v_lshlrev_b32 v122, 16, v237
  v_and_b32 v123, 0xffff0000, v237
  v_lshlrev_b32 v124, 16, v238
  v_and_b32 v125, 0xffff0000, v238
  v_lshlrev_b32 v126, 16, v239
  v_and_b32 v127, 0xffff0000, v239
  v_pk_fma_f32 v[120:121], v[184:185], v[248:249], v[120:121]
  v_pk_fma_f32 v[122:123], v[186:187], v[250:251], v[122:123]
  v_pk_fma_f32 v[124:125], v[188:189], v[252:253], v[124:125]
  v_pk_fma_f32 v[126:127], v[190:191], v[254:255], v[126:127]
  v_cvt_pk_bf16_f32 v236, v120, v121
  v_cvt_pk_bf16_f32 v237, v122, v123
  v_cvt_pk_bf16_f32 v238, v124, v125
  v_cvt_pk_bf16_f32 v239, v126, v127
  s_mov_b32 s38, 32768
  buffer_store_dwordx4 v[236:239], v10, s[16:19], s38 offen offset:64 sc1
  s_endpgm
g4_f_prod:
  s_sub_u32 s28, s28, 4
  v_lshlrev_b32 v17, 3, v16
  s_lshl_b32 s39, s28, 1
  v_add_u32 v17, s39, v17
  v_lshlrev_b32 v17, 11, v17
  v_and_b32 v18, 15, v0
  v_lshlrev_b32 v18, 4, v18
  v_add_u32 v4, v17, v18
  v_add_u32 v5, 992, v4
  v_add_u32 v6, 65536, v4
  v_add_u32 v7, 66528, v4
  s_and_b32 s38, s28, 1
  s_lshl_b32 s38, s38, 12
  v_add_u32 v8, s38, v3
  s_mul_i32 s42, s28, 2112
  s_lshl_b32 s43, s28, 12
  s_add_u32 s43, s43, 16896
  s_waitcnt lgkmcnt(0)
  s_lshl_b32 s39, s36, 8
  s_mul_i32 s38, s56, 3670016
  s_add_u32 s39, s39, s38
  s_add_u32 s8, s4, s39
  s_addc_u32 s9, s5, 0
  s_mov_b32 s10, 0x380000
  s_mov_b32 s11, 0x20000
  s_mul_i32 s39, s37, 917504
  s_mul_i32 s38, s56, 229376
  s_add_u32 s39, s39, s38
  s_lshr_b32 s38, s28, 1
  s_mul_i32 s38, s38, 458752
  s_add_u32 s39, s39, s38
  s_add_u32 s12, s32, s39
  s_addc_u32 s13, s33, 0
  s_add_u32 s12, s12, 0x1500000
  s_addc_u32 s13, s13, 0
  s_mov_b32 s14, 0x38000
  s_mov_b32 s15, 0x20000
  s_mov_b32 s29, 0
  s_mov_b32 s30, 0
  s_add_u32 m0, s42, 0
  s_add_u32 s44, s42, 8448
  buffer_load_dwordx4 v4, s[8:11], s29 offen lds
  buffer_load_dwordx4 v5, s[8:11], s29 offen offset:1056 lds
  s_mov_b32 m0, s44
  s_add_u32 s45, s43, 0
  buffer_load_dwordx4 v6, s[8:11], s29 offen lds
  buffer_load_dwordx4 v7, s[8:11], s29 offen offset:1056 lds
  s_add_u32 s29, s29, 131072
  s_add_u32 m0, s42, 33280
  s_add_u32 s44, s42, 41728
  buffer_load_dwordx4 v4, s[8:11], s29 offen lds
  buffer_load_dwordx4 v5, s[8:11], s29 offen offset:1056 lds
  s_mov_b32 m0, s44
  s_add_u32 s45, s43, 33280
  buffer_load_dwordx4 v6, s[8:11], s29 offen lds
  buffer_load_dwordx4 v7, s[8:11], s29 offen offset:1056 lds
  s_add_u32 s29, s29, 131072
  s_add_u32 m0, s42, 66560
  s_add_u32 s44, s42, 75008
  buffer_load_dwordx4 v4, s[8:11], s29 offen lds
  buffer_load_dwordx4 v5, s[8:11], s29 offen offset:1056 lds
  s_mov_b32 m0, s44
  s_add_u32 s45, s43, 66560
  buffer_load_dwordx4 v6, s[8:11], s29 offen lds
  buffer_load_dwordx4 v7, s[8:11], s29 offen offset:1056 lds
  s_add_u32 s29, s29, 131072
  s_add_u32 m0, s42, 99840
  s_add_u32 s44, s42, 108288
  buffer_load_dwordx4 v4, s[8:11], s29 offen lds
  buffer_load_dwordx4 v5, s[8:11], s29 offen offset:1056 lds
  s_mov_b32 m0, s44
  s_add_u32 s45, s43, 99840
  buffer_load_dwordx4 v6, s[8:11], s29 offen lds
  buffer_load_dwordx4 v7, s[8:11], s29 offen offset:1056 lds
  s_add_u32 s29, s29, 131072
  s_cmp_lg_u32 s28, 0
  s_cbranch_scc1 g4_f_nodep
  s_lshr_b32 s38, s37, 1
  s_lshl_b32 s38, s38, 1
  s_add_u32 s38, s38, s56
  s_lshl_b32 s38, s38, 7
  v_mov_b32 v21, s38
  s_mov_b32 s46, 1048576
g4_f_dep:
  buffer_load_dword v22, v21, s[60:63], 0 offen sc1
  s_waitcnt vmcnt(0)
  v_readfirstlane_b32 s47, v22
  s_cmp_ge_u32 s47, 16
  s_cbranch_scc1 g4_f_nodep
  s_sub_u32 s46, s46, 1
  s_cmp_lg_u32 s46, 0
  s_cbranch_scc0 g4_f_nodep
  s_sleep 1
  s_branch g4_f_dep
g4_f_nodep:
  s_barrier
  s_add_u32 m0, s43, 0
  s_nop 0
  buffer_load_dwordx4 v8, s[12:15], s30 offen offset:0 sc1 lds
  buffer_load_dwordx4 v8, s[12:15], s30 offen offset:1024 sc1 lds
  buffer_load_dwordx4 v8, s[12:15], s30 offen offset:2048 sc1 lds
  buffer_load_dwordx4 v8, s[12:15], s30 offen offset:3072 sc1 lds
  s_add_u32 s30, s30, 8192
  s_add_u32 m0, s43, 33280
  s_nop 0
  buffer_load_dwordx4 v8, s[12:15], s30 offen offset:0 sc1 lds
  buffer_load_dwordx4 v8, s[12:15], s30 offen offset:1024 sc1 lds
  buffer_load_dwordx4 v8, s[12:15], s30 offen offset:2048 sc1 lds
  buffer_load_dwordx4 v8, s[12:15], s30 offen offset:3072 sc1 lds
  s_add_u32 s30, s30, 8192
  s_add_u32 m0, s43, 66560
  s_nop 0
  buffer_load_dwordx4 v8, s[12:15], s30 offen offset:0 sc1 lds
  buffer_load_dwordx4 v8, s[12:15], s30 offen offset:1024 sc1 lds
  buffer_load_dwordx4 v8, s[12:15], s30 offen offset:2048 sc1 lds
  buffer_load_dwordx4 v8, s[12:15], s30 offen offset:3072 sc1 lds
  s_add_u32 s30, s30, 8192
  s_add_u32 m0, s43, 99840
  s_nop 0
  buffer_load_dwordx4 v8, s[12:15], s30 offen offset:0 sc1 lds
  buffer_load_dwordx4 v8, s[12:15], s30 offen offset:1024 sc1 lds
  buffer_load_dwordx4 v8, s[12:15], s30 offen offset:2048 sc1 lds
  buffer_load_dwordx4 v8, s[12:15], s30 offen offset:3072 sc1 lds
  s_add_u32 s30, s30, 8192
  s_waitcnt vmcnt(12)
  s_barrier
  s_waitcnt vmcnt(8)
  s_barrier
  s_add_u32 m0, s42, 0
  s_add_u32 s44, s42, 8448
  buffer_load_dwordx4 v4, s[8:11], s29 offen lds
  buffer_load_dwordx4 v5, s[8:11], s29 offen offset:1056 lds
  s_mov_b32 m0, s44
  s_add_u32 s45, s43, 0
  buffer_load_dwordx4 v6, s[8:11], s29 offen lds
  buffer_load_dwordx4 v7, s[8:11], s29 offen offset:1056 lds
  s_mov_b32 m0, s45
  s_add_u32 s29, s29, 131072
  buffer_load_dwordx4 v8, s[12:15], s30 offen offset:0 sc1 lds
  buffer_load_dwordx4 v8, s[12:15], s30 offen offset:1024 sc1 lds
  buffer_load_dwordx4 v8, s[12:15], s30 offen offset:2048 sc1 lds
  buffer_load_dwordx4 v8, s[12:15], s30 offen offset:3072 sc1 lds
  s_add_u32 s30, s30, 8192
  s_waitcnt vmcnt(12)
  s_barrier
  s_add_u32 m0, s42, 33280
  s_add_u32 s44, s42, 41728
  buffer_load_dwordx4 v4, s[8:11], s29 offen lds
  buffer_load_dwordx4 v5, s[8:11], s29 offen offset:1056 lds
  s_mov_b32 m0, s44
  s_add_u32 s45, s43, 33280
  buffer_load_dwordx4 v6, s[8:11], s29 offen lds
  buffer_load_dwordx4 v7, s[8:11], s29 offen offset:1056 lds
  s_mov_b32 m0, s45
  s_add_u32 s29, s29, 131072
  buffer_load_dwordx4 v8, s[12:15], s30 offen offset:0 sc1 lds
  buffer_load_dwordx4 v8, s[12:15], s30 offen offset:1024 sc1 lds
  buffer_load_dwordx4 v8, s[12:15], s30 offen offset:2048 sc1 lds
  buffer_load_dwordx4 v8, s[12:15], s30 offen offset:3072 sc1 lds
  s_add_u32 s30, s30, 8192
  s_waitcnt vmcnt(16)
  s_barrier
  s_add_u32 m0, s42, 66560
  s_add_u32 s44, s42, 75008
  buffer_load_dwordx4 v4, s[8:11], s29 offen lds
  buffer_load_dwordx4 v5, s[8:11], s29 offen offset:1056 lds
  s_mov_b32 m0, s44
  s_add_u32 s45, s43, 66560
  buffer_load_dwordx4 v6, s[8:11], s29 offen lds
  buffer_load_dwordx4 v7, s[8:11], s29 offen offset:1056 lds
  s_mov_b32 m0, s45
  s_add_u32 s29, s29, 131072
  buffer_load_dwordx4 v8, s[12:15], s30 offen offset:0 sc1 lds
  buffer_load_dwordx4 v8, s[12:15], s30 offen offset:1024 sc1 lds
  buffer_load_dwordx4 v8, s[12:15], s30 offen offset:2048 sc1 lds
  buffer_load_dwordx4 v8, s[12:15], s30 offen offset:3072 sc1 lds
  s_add_u32 s30, s30, 8192
  s_waitcnt vmcnt(16)
  s_barrier
  s_add_u32 m0, s42, 99840
  s_add_u32 s44, s42, 108288
  buffer_load_dwordx4 v4, s[8:11], s29 offen lds
  buffer_load_dwordx4 v5, s[8:11], s29 offen offset:1056 lds
  s_mov_b32 m0, s44
  s_add_u32 s45, s43, 99840
  buffer_load_dwordx4 v6, s[8:11], s29 offen lds
  buffer_load_dwordx4 v7, s[8:11], s29 offen offset:1056 lds
  s_mov_b32 m0, s45
  s_add_u32 s29, s29, 131072
  buffer_load_dwordx4 v8, s[12:15], s30 offen offset:0 sc1 lds
  buffer_load_dwordx4 v8, s[12:15], s30 offen offset:1024 sc1 lds
  buffer_load_dwordx4 v8, s[12:15], s30 offen offset:2048 sc1 lds
  buffer_load_dwordx4 v8, s[12:15], s30 offen offset:3072 sc1 lds
  s_add_u32 s30, s30, 8192
  s_mov_b32 s31, 6
g4_f_ploop:
  s_waitcnt vmcnt(16)
  s_barrier
  s_add_u32 m0, s42, 0
  s_add_u32 s44, s42, 8448
  buffer_load_dwordx4 v4, s[8:11], s29 offen lds
  buffer_load_dwordx4 v5, s[8:11], s29 offen offset:1056 lds
  s_mov_b32 m0, s44
  s_add_u32 s45, s43, 0
  buffer_load_dwordx4 v6, s[8:11], s29 offen lds
  buffer_load_dwordx4 v7, s[8:11], s29 offen offset:1056 lds
  s_mov_b32 m0, s45
  s_add_u32 s29, s29, 131072
  buffer_load_dwordx4 v8, s[12:15], s30 offen offset:0 sc1 lds
  buffer_load_dwordx4 v8, s[12:15], s30 offen offset:1024 sc1 lds
  buffer_load_dwordx4 v8, s[12:15], s30 offen offset:2048 sc1 lds
  buffer_load_dwordx4 v8, s[12:15], s30 offen offset:3072 sc1 lds
  s_add_u32 s30, s30, 8192
  s_waitcnt vmcnt(16)
  s_barrier
  s_add_u32 m0, s42, 33280
  s_add_u32 s44, s42, 41728
  buffer_load_dwordx4 v4, s[8:11], s29 offen lds
  buffer_load_dwordx4 v5, s[8:11], s29 offen offset:1056 lds
  s_mov_b32 m0, s44
  s_add_u32 s45, s43, 33280
  buffer_load_dwordx4 v6, s[8:11], s29 offen lds
  buffer_load_dwordx4 v7, s[8:11], s29 offen offset:1056 lds
  s_mov_b32 m0, s45
  s_add_u32 s29, s29, 131072
  buffer_load_dwordx4 v8, s[12:15], s30 offen offset:0 sc1 lds
  buffer_load_dwordx4 v8, s[12:15], s30 offen offset:1024 sc1 lds
  buffer_load_dwordx4 v8, s[12:15], s30 offen offset:2048 sc1 lds
  buffer_load_dwordx4 v8, s[12:15], s30 offen offset:3072 sc1 lds
  s_add_u32 s30, s30, 8192
  s_waitcnt vmcnt(16)
  s_barrier
  s_add_u32 m0, s42, 66560
  s_add_u32 s44, s42, 75008
  buffer_load_dwordx4 v4, s[8:11], s29 offen lds
  buffer_load_dwordx4 v5, s[8:11], s29 offen offset:1056 lds
  s_mov_b32 m0, s44
  s_add_u32 s45, s43, 66560
  buffer_load_dwordx4 v6, s[8:11], s29 offen lds
  buffer_load_dwordx4 v7, s[8:11], s29 offen offset:1056 lds
  s_mov_b32 m0, s45
  s_add_u32 s29, s29, 131072
  buffer_load_dwordx4 v8, s[12:15], s30 offen offset:0 sc1 lds
  buffer_load_dwordx4 v8, s[12:15], s30 offen offset:1024 sc1 lds
  buffer_load_dwordx4 v8, s[12:15], s30 offen offset:2048 sc1 lds
  buffer_load_dwordx4 v8, s[12:15], s30 offen offset:3072 sc1 lds
  s_add_u32 s30, s30, 8192
  s_waitcnt vmcnt(16)
  s_barrier
  s_add_u32 m0, s42, 99840
  s_add_u32 s44, s42, 108288
  buffer_load_dwordx4 v4, s[8:11], s29 offen lds
  buffer_load_dwordx4 v5, s[8:11], s29 offen offset:1056 lds
  s_mov_b32 m0, s44
  s_add_u32 s45, s43, 99840
  buffer_load_dwordx4 v6, s[8:11], s29 offen lds
  buffer_load_dwordx4 v7, s[8:11], s29 offen offset:1056 lds
  s_mov_b32 m0, s45
  s_add_u32 s29, s29, 131072
  buffer_load_dwordx4 v8, s[12:15], s30 offen offset:0 sc1 lds
  buffer_load_dwordx4 v8, s[12:15], s30 offen offset:1024 sc1 lds
  buffer_load_dwordx4 v8, s[12:15], s30 offen offset:2048 sc1 lds
  buffer_load_dwordx4 v8, s[12:15], s30 offen offset:3072 sc1 lds
  s_add_u32 s30, s30, 8192
  s_sub_u32 s31, s31, 1
  s_cmp_lg_u32 s31, 0
  s_cbranch_scc1 g4_f_ploop
kc_kernel_end:
  s_endpgm

code_end_label:
.section .rodata,"a"
.p2align 6
.amdhsa_kernel ka_kernel
  .amdhsa_next_free_vgpr 128
  .amdhsa_next_free_sgpr 102
  .amdhsa_accum_offset 128
  .amdhsa_group_segment_fixed_size 0
  .amdhsa_kernarg_size 112
  .amdhsa_user_sgpr_count 2
  .amdhsa_user_sgpr_kernarg_segment_ptr 1
  .amdhsa_system_sgpr_workgroup_id_x 1
  .amdhsa_float_denorm_mode_32 3
  .amdhsa_float_denorm_mode_16_64 3
.end_amdhsa_kernel

.p2align 6
.amdhsa_kernel kb_kernel
  .amdhsa_next_free_vgpr 256
  .amdhsa_next_free_sgpr 102
  .amdhsa_accum_offset 256
  .amdhsa_group_segment_fixed_size 0
  .amdhsa_kernarg_size 112
  .amdhsa_user_sgpr_count 2
  .amdhsa_user_sgpr_kernarg_segment_ptr 1
  .amdhsa_system_sgpr_workgroup_id_x 1
  .amdhsa_float_denorm_mode_32 3
  .amdhsa_float_denorm_mode_16_64 3
.end_amdhsa_kernel

.p2align 6
.amdhsa_kernel kc_kernel
  .amdhsa_next_free_vgpr 256
  .amdhsa_next_free_sgpr 102
  .amdhsa_accum_offset 256
  .amdhsa_group_segment_fixed_size 0
  .amdhsa_kernarg_size 112
  .amdhsa_user_sgpr_count 2
  .amdhsa_user_sgpr_kernarg_segment_ptr 1
  .amdhsa_system_sgpr_workgroup_id_x 1
  .amdhsa_float_denorm_mode_32 3
  .amdhsa_float_denorm_mode_16_64 3
.end_amdhsa_kernel
```
